```python
import torch

def _softmax(x, axis=-1):
    return torch.softmax(x, dim=axis)
def _gelu(x):
    return torch.nn.functional.gelu(x, approximate="tanh")
def _silu(x):
    return torch.nn.functional.silu(x)
def _sigmoid(x):
    return torch.sigmoid(x)
def _layernorm(x, axis=-1, eps=1e-5):
    m = x.mean(dim=axis, keepdim=True)
    v = x.var(dim=axis, keepdim=True, unbiased=False)
    return (x - m) / torch.sqrt(v + eps)
def _scatter_add(tgt, idx, src, axis=0):
    return tgt.clone().index_add_(axis, idx, src)
def _segment_sum(src, seg, n):
    out = torch.zeros((n,) + src.shape[1:], dtype=src.dtype)
    return out.index_add_(0, seg, src)
def _pad(x, pw):
    flat = tuple(v for pair in reversed(pw) for v in pair)
    return torch.nn.functional.pad(x, flat)

kernel_name = 'recurrent_scan__ssm_conv_h3__geglu_ffn__prompt'

def setup_inputs():

    _w = (lambda a: (lambda t: t.to(torch.bfloat16) if t.is_floating_point() else t)(torch.as_tensor(a)))
    def _A_setup():
        B, S, D = 1, 2048, 512
        ks = 4
        return {
            "q": _w((lambda *s: torch.randn(*s, dtype=torch.bfloat16) * 0.05)(B, S, D)),
            "k": _w((lambda *s: torch.randn(*s, dtype=torch.bfloat16) * 0.2)(B, S, D)),
            "v": _w((lambda *s: torch.randn(*s, dtype=torch.bfloat16) * 0.2)(B, S, D)),
            "shift_k": _w((lambda *s: torch.randn(*s, dtype=torch.bfloat16) * 0.2)(D, ks) * 0.5),
            "ssm_k": _w((lambda *s: torch.randn(*s, dtype=torch.bfloat16) * 0.2)(D, S) * (1.0 / S ** 0.5)),
            "ssm_D": _w((lambda *s: torch.randn(*s, dtype=torch.bfloat16) * 0.2)(D)),
        }
    _A_in = _A_setup()

    def _B_setup():
        B, S, D, F = 1, 2048, 512, 1792
        return {
            "x": _w((lambda *s: torch.randn(*s, dtype=torch.bfloat16) * 0.05)(B, S, D)),
            "w_gate": _w((lambda *s: torch.randn(*s, dtype=torch.bfloat16) * 0.1)(D, F)),
            "w_up": _w((lambda *s: torch.randn(*s, dtype=torch.bfloat16) * 0.1)(D, F)),
            "w_down": _w((lambda *s: torch.randn(*s, dtype=torch.bfloat16) * 0.1)(F, D)),
        }
    _B_in = _B_setup()

    return {
        "A_q": _A_in["q"],
        "A_k": _A_in["k"],
        "A_v": _A_in["v"],
        "A_shift_k": _A_in["shift_k"],
        "A_ssm_k": _A_in["ssm_k"],
        "A_ssm_D": _A_in["ssm_D"],
        "B_x": _B_in["x"],
        "B_w_gate": _B_in["w_gate"],
        "B_w_up": _B_in["w_up"],
        "B_w_down": _B_in["w_down"],
    }

def reference(A_q, A_k, A_v, A_shift_k, A_ssm_k, A_ssm_D, B_x, B_w_gate, B_w_up, B_w_down):
    def _A_ref(q, k, v, shift_k, ssm_k, ssm_D):
        B, S, D = q.shape
        ks = shift_k.shape[-1]
        k_pad = _pad(k, ((0, 0), (ks - 1, 0), (0, 0)))
        k_shift = torch.zeros_like(k)
        for t in range(ks):
            k_shift = k_shift + k_pad[:, t:t + S, :] * shift_k[:, ks - 1 - t][None, None, :]
        kv = k_shift * v
        L = 2 * S
        kv_pad = _pad(kv, ((0, 0), (0, S), (0, 0)))
        kf_pad = _pad(ssm_k, ((0, 0), (0, S)))
        kv_f = (lambda x, axes=(-2,-1): torch.fft.rfft2(x.float(), dim=axes))(kv_pad[:, None, :, :], axes=(1, 2))
        kf_f = (lambda x, axes=(-2,-1): torch.fft.rfft2(x.float(), dim=axes))(kf_pad[:, None, :], axes=(1, 2))
        kf_f = (lambda x, *d: x.permute(*d))(kf_f, 1, 2, 0)
        y_f = kv_f * kf_f[None, :, :, :]
        y = (lambda x, s, axes=(-2,-1): torch.fft.irfft2(x, s=s, dim=axes).to(torch.bfloat16))(y_f, (1, L), axes=(1, 2))[:, 0, :S, :]
        y = y + kv * ssm_D[None, None, :]
        return q * y

    def _B_ref(x, w_gate, w_up, w_down):
        return (_gelu(x @ w_gate) * (x @ w_up)) @ w_down

    x = A_q
    xn = _layernorm(x, axis=-1)
    s = _A_ref(xn, A_k, A_v, A_shift_k, A_ssm_k, A_ssm_D)
    g = _silu(_B_ref(xn, B_w_gate, B_w_up, B_w_down))
    return x + s * g
```

```asm
; @launch grid=(256,1,1) block=(512,1,1) lds=163840
.amdgcn_target "amdgcn-amd-amdhsa--gfx950"
.text
.globl recurrent_scan__ssm_conv_h3__geglu_ffn__prompt_kernel
.p2align 8
.type recurrent_scan__ssm_conv_h3__geglu_ffn__prompt_kernel,@function
recurrent_scan__ssm_conv_h3__geglu_ffn__prompt_kernel:
    s_cmp_ge_u32 s2, 256
    s_cbranch_scc1 L_end
    s_load_dwordx16 s[72:87], s[0:1], 0
    s_load_dwordx8 s[88:95], s[0:1], 64
    s_load_dwordx2 s[96:97], s[0:1], 96
    v_lshrrev_b32 v1, 6, v0
    v_and_b32 v0, 63, v0
    v_readfirstlane_b32 s3, v1
    s_and_b32 s63, s2, 7
    s_lshr_b32 s61, s2, 3
    s_and_b32 s101, s63, 1
    s_lshr_b32 s98, s63, 1
    s_and_b32 s62, s61, 3
    s_lshr_b32 s56, s61, 2
    s_lshl_b32 s71, s98, 2
    s_add_u32 s71, s71, s62
    s_lshl_b32 s48, s71, 1
    s_add_u32 s48, s48, s101
    s_add_u32 s49, s56, 7
    s_and_b32 s49, s49, 7
    s_mul_i32 s64, s101, 7
    s_add_u32 s64, s64, s49
    s_xor_b32 s50, s62, s56
    s_and_b32 s50, s50, 3
    s_lshl_b32 s99, s98, 2
    s_and_b32 s99, s99, 4
    s_or_b32 s50, s50, s99
    s_lshl_b32 s99, s63, 5
    s_add_u32 s61, s61, s99
    s_and_b32 s51, s3, 1
    s_lshr_b32 s52, s3, 1
    s_lshr_b32 s99, s3, 2
    s_and_b32 s100, s3, 3
    s_lshl_b32 s4, s71, 17
    s_lshl_b32 s6, s99, 16
    s_add_u32 s4, s4, s6
    s_lshl_b32 s6, s100, 10
    s_add_u32 s4, s4, s6
    s_mul_i32 s5, s3, 28672
    s_lshl_b32 s6, s64, 8
    s_add_u32 s5, s5, s6
    s_lshl_b32 s54, s3, 11
    s_and_b32 s6, s50, 1
    s_and_b32 s7, s98, 2
    s_or_b32 s6, s6, s7
    s_add_u32 s60, s51, 1
    s_cmp_eq_u32 s6, s52
    s_cselect_b32 s60, s60, 0
    s_lshr_b32 s70, s49, 2
    s_mov_b32 s55, 0
    s_mov_b32 s10, 2097152
    s_mov_b32 s11, 0x20000
    s_mov_b32 s14, 1835008
    s_mov_b32 s15, 0x20000
    s_mov_b32 s18, 1835008
    s_mov_b32 s19, 0x20000
    s_mov_b32 s22, 1835008
    s_mov_b32 s23, 0x20000
    s_mov_b32 s26, 33554432
    s_mov_b32 s27, 0x20000
    s_mov_b32 s30, 2097152
    s_mov_b32 s31, 0x20000
    s_mov_b32 s34, 4096
    s_mov_b32 s35, 0x20000
    s_mov_b32 s38, 2097152
    s_mov_b32 s39, 0x20000
    s_mov_b32 s42, 2097152
    s_mov_b32 s43, 0x20000
    s_mov_b32 s46, 4096
    s_mov_b32 s47, 0x20000
    v_lshrrev_b32 v20, 3, v0
    v_lshrrev_b32 v21, 4, v0
    v_and_b32 v22, 7, v0
    v_xor_b32 v23, v22, v21
    v_lshlrev_b32 v23, 4, v23
    v_lshl_add_u32 v1, v20, 12, v23
    v_xor_b32 v2, 64, v1
    v_add_u32 v2, 31744, v2
    v_bfe_u32 v24, v0, 2, 2
    v_and_b32 v25, 3, v0
    v_xor_b32 v23, v24, v21
    v_lshlrev_b32 v23, 6, v23
    v_lshl_add_u32 v23, v25, 4, v23
    v_mul_u32_u24 v3, 3584, v21
    v_add_u32 v3, v3, v23
    v_add_u32 v4, 13312, v3
    v_lshlrev_b32 v5, 4, v0
    s_lshl_b32 s58, s61, 1
    s_add_u32 s58, s58, s99
    s_lshl_b32 s58, s58, 12
    s_lshl_b32 s59, s61, 2
    s_waitcnt lgkmcnt(0)
    s_mov_b64 s[8:9], s[72:73]
    s_mov_b64 s[12:13], s[86:87]
    s_mov_b64 s[16:17], s[88:89]
    s_mov_b64 s[36:37], s[74:75]
    s_mov_b64 s[40:41], s[76:77]
    s_mov_b64 s[24:25], s[96:97]
    s_mov_b64 s[44:45], s[78:79]
    s_mov_b64 s[20:21], s[90:91]
    s_mov_b64 s[28:29], s[92:93]
    s_add_u32 s32, s80, s58
    s_addc_u32 s33, s81, 0
    s_load_dword s65, s[82:83], s59
    s_lshl_b32 s59, s100, 10
    s_max_u32 s59, s59, 4
    s_add_u32 s58, s58, s59
    s_sub_u32 s58, s58, 4
    s_load_dword s55, s[80:81], s58
    s_cmp_eq_u32 s56, 0
    s_cbranch_scc1 L_aux
    s_xor_b32 s6, s50, 0
    s_mul_i32 s7, s6, 229376
    s_add_u32 s7, s7, s5
    s_lshl_b32 s6, s6, 7
    s_add_u32 m0, s54, 0
    s_add_u32 s6, s6, s4
    buffer_load_dwordx4 v1, s[8:11], s6 offen lds
    buffer_load_dwordx4 v2, s[8:11], s6 offen offset:1024 lds
    s_add_u32 m0, s54, 16384
    s_nop 0
    buffer_load_dwordx4 v3, s[12:15], s7 offen lds
    buffer_load_dwordx4 v4, s[12:15], s7 offen offset:1024 lds
    s_add_u32 m0, s54, 32768
    s_nop 0
    buffer_load_dwordx4 v3, s[16:19], s7 offen lds
    buffer_load_dwordx4 v4, s[16:19], s7 offen offset:1024 lds
    v_and_b32 v23, 3, v20
    v_lshrrev_b32 v26, 5, v0
    v_lshl_add_u32 v23, v26, 3, v23
    v_lshlrev_b32 v26, 4, v22
    v_lshl_add_u32 v214, v23, 10, v26
    s_mov_b32 s101, s63
    s_lshl_b32 s58, s62, 1
    s_add_u32 s58, s58, s99
    s_mul_i32 s59, s58, 7
    s_add_u32 s59, s59, s49
    s_mul_i32 s44, s101, 56
    s_add_u32 s44, s44, s59
    s_lshl_b32 s44, s44, 12
    s_lshl_b32 s7, s100, 8
    s_add_u32 s44, s44, s7
    s_add_u32 s44, s44, 3145728
    s_lshl_b32 s59, s59, 15
    s_lshl_b32 s7, s51, 12
    s_add_u32 s59, s59, s7
    s_lshl_b32 s7, s52, 14
    s_and_b32 s7, s7, 0x4000
    s_add_u32 s59, s59, s7
    s_lshl_b32 s7, s101, 7
    s_add_u32 s45, s59, s7
    s_lshl_b32 s58, s3, 10
    s_add_u32 s47, s58, 147456
    s_cmp_ge_u32 s3, 4
    s_cbranch_scc1 L_wux
    v_mul_u32_u24 v112, 0x9e3779, v0
    v_and_b32 v112, 0x807f807f, v112
    v_or_b32 v112, 0x3f003f00, v112
    v_xor_b32 v113, 0x1b8058, v112
    v_xor_b32 v114, 0x62800e, v113
    v_xor_b32 v115, 0x298044, v114
    v_xor_b32 v116, 0x8070807a, v115
    v_xor_b32 v117, 0x80370031, v116
    v_xor_b32 v118, 0x807e0067, v117
    v_xor_b32 v119, 0x8045001d, v118
    s_mov_b32 s58, 15
L_wu:
    v_mfma_f32_32x32x16_bf16 v[32:47], v[112:115], v[112:115], 0
    v_mfma_f32_32x32x16_bf16 v[48:63], v[116:119], v[112:115], 0
    v_mfma_f32_32x32x16_bf16 v[64:79], v[112:115], v[116:119], 0
    v_mfma_f32_32x32x16_bf16 v[80:95], v[116:119], v[116:119], 0
    s_sub_u32 s58, s58, 1
    s_cmp_lg_u32 s58, 0
    s_cbranch_scc1 L_wu
L_wux:
    s_mov_b32 m0, s47
    s_nop 0
    buffer_load_dwordx4 v214, s[20:23], s45 offen nt lds
    v_lshlrev_b32 v23, 7, v24
    v_lshl_add_u32 v23, v21, 5, v23
    v_lshl_add_u32 v23, v25, 3, v23
    v_add_u32 v212, s47, v23
    buffer_load_dword v17, off, s[24:27], 0 offset:0 sc1
    s_lshl_b32 s98, s48, 3
    s_add_u32 s98, s98, s56
    s_lshl_b32 s98, s98, 3
    s_add_u32 s98, s98, s3
    s_lshl_b32 s58, s98, 10
    buffer_load_dwordx4 v[200:203], v5, s[8:11], s58 offen
    s_xor_b32 s6, s50, 1
    s_mul_i32 s7, s6, 229376
    s_add_u32 s7, s7, s5
    s_lshl_b32 s6, s6, 7
    s_add_u32 m0, s54, 49152
    s_add_u32 s6, s6, s4
    buffer_load_dwordx4 v1, s[8:11], s6 offen lds
    buffer_load_dwordx4 v2, s[8:11], s6 offen offset:1024 lds
    v_and_b32 v23, 15, v0
    v_lshlrev_b32 v23, 4, v23
    v_lshl_add_u32 v213, v21, 10, v23
    v_and_b32 v24, 31, v0
    v_lshrrev_b32 v25, 5, v0
    v_bfe_u32 v22, v0, 1, 3
    v_xor_b32 v22, v22, v25
    v_lshlrev_b32 v22, 4, v22
    v_lshl_add_u32 v22, v24, 7, v22
    s_lshl_b32 s6, s51, 13
    v_add_u32 v6, s6, v22
    v_xor_b32 v7, 32, v6
    v_xor_b32 v8, 64, v6
    v_xor_b32 v9, 96, v6
    v_add_u32 v10, 98304, v6
    v_add_u32 v11, 98304, v7
    v_add_u32 v12, 98304, v8
    v_add_u32 v13, 98304, v9
    v_bfe_u32 v23, v0, 2, 2
    v_lshl_add_u32 v24, v25, 3, v23
    v_lshlrev_b32 v24, 8, v24
    v_xor_b32 v23, s52, v23
    v_lshl_add_u32 v24, v23, 6, v24
    v_bfe_u32 v23, v0, 4, 1
    v_lshl_add_u32 v24, v23, 5, v24
    v_and_b32 v23, 3, v0
    v_lshl_add_u32 v24, v23, 3, v24
    v_add_u32 v14, 16384, v24
    v_add_u32 v15, 65536, v24
    v_add_u32 v16, 114688, v24
    v_mov_b32 v236, 0x3f803f80
    v_mov_b32 v237, 0x3f803f80
    v_mov_b32 v238, 0x3f803f80
    v_mov_b32 v239, 0x3f803f80
    s_waitcnt vmcnt(5) lgkmcnt(0)
    s_barrier
    ds_read_b64_tr_b16 v[96:97], v14 offset:0
    ds_read_b64_tr_b16 v[98:99], v14 offset:1024
    ds_read_b128 v[104:107], v6 offset:0
    ds_read_b64_tr_b16 v[100:101], v14 offset:16384
    ds_read_b64_tr_b16 v[102:103], v14 offset:17408
    ds_read_b128 v[108:111], v6 offset:4096
    s_xor_b32 s6, s50, 1
    s_mul_i32 s7, s6, 229376
    s_add_u32 s7, s7, s5
    s_lshl_b32 s6, s6, 7
    s_add_u32 m0, s54, 65536
    s_nop 0
    buffer_load_dwordx4 v3, s[12:15], s7 offen lds
    buffer_load_dwordx4 v4, s[12:15], s7 offen offset:1024 lds
    s_add_u32 m0, s54, 81920
    s_nop 0
    buffer_load_dwordx4 v3, s[16:19], s7 offen lds
    buffer_load_dwordx4 v4, s[16:19], s7 offen offset:1024 lds
    ds_read_b64_tr_b16 v[112:113], v14 offset:4096
    ds_read_b64_tr_b16 v[114:115], v14 offset:5120
    ds_read_b128 v[120:123], v7 offset:0
    ds_read_b64_tr_b16 v[116:117], v14 offset:20480
    ds_read_b64_tr_b16 v[118:119], v14 offset:21504
    ds_read_b128 v[124:127], v7 offset:4096
    s_waitcnt lgkmcnt(6)
    v_mfma_f32_32x32x16_bf16 v[32:47], v[96:99], v[104:107], 0
    s_xor_b32 s6, s50, 2
    s_mul_i32 s7, s6, 229376
    s_add_u32 s7, s7, s5
    s_lshl_b32 s6, s6, 7
    s_add_u32 m0, s54, 98304
    s_add_u32 s6, s6, s4
    buffer_load_dwordx4 v1, s[8:11], s6 offen lds
    v_mfma_f32_32x32x16_bf16 v[64:79], v[100:103], v[104:107], 0
    v_mfma_f32_32x32x16_bf16 v[48:63], v[96:99], v[108:111], 0
    buffer_load_dwordx4 v2, s[8:11], s6 offen offset:1024 lds
    v_mfma_f32_32x32x16_bf16 v[80:95], v[100:103], v[108:111], 0
    s_bitcmp1_b32 s60, 0
    s_cbranch_scc0 L_cs0_0
    v_dot2_f32_bf16 v244, v96, v236, 0
    v_dot2_f32_bf16 v245, v97, v236, 0
    v_dot2_f32_bf16 v244, v98, v236, v244
    v_dot2_f32_bf16 v245, v99, v236, v245
L_cs0_0:
    s_bitcmp1_b32 s60, 1
    s_cbranch_scc0 L_cs0_1
    v_dot2_f32_bf16 v244, v100, v236, 0
    v_dot2_f32_bf16 v245, v101, v236, 0
    v_dot2_f32_bf16 v244, v102, v236, v244
    v_dot2_f32_bf16 v245, v103, v236, v245
L_cs0_1:
    ds_read_b64_tr_b16 v[96:97], v14 offset:8192
    ds_read_b64_tr_b16 v[98:99], v14 offset:9216
    ds_read_b128 v[104:107], v8 offset:0
    ds_read_b64_tr_b16 v[100:101], v14 offset:24576
    ds_read_b64_tr_b16 v[102:103], v14 offset:25600
    ds_read_b128 v[108:111], v8 offset:4096
    s_waitcnt lgkmcnt(6)
    v_mfma_f32_32x32x16_bf16 v[32:47], v[112:115], v[120:123], v[32:47]
    s_add_u32 m0, s54, 114688
    s_nop 0
    buffer_load_dwordx4 v3, s[12:15], s7 offen lds
    v_mfma_f32_32x32x16_bf16 v[64:79], v[116:119], v[120:123], v[64:79]
    v_mfma_f32_32x32x16_bf16 v[48:63], v[112:115], v[124:127], v[48:63]
    buffer_load_dwordx4 v4, s[12:15], s7 offen offset:1024 lds
    v_mfma_f32_32x32x16_bf16 v[80:95], v[116:119], v[124:127], v[80:95]
    s_bitcmp1_b32 s60, 0
    s_cbranch_scc0 L_cs1_0
    v_dot2_f32_bf16 v244, v112, v236, v244
    v_dot2_f32_bf16 v245, v113, v236, v245
    v_dot2_f32_bf16 v244, v114, v236, v244
    v_dot2_f32_bf16 v245, v115, v236, v245
L_cs1_0:
    s_bitcmp1_b32 s60, 1
    s_cbranch_scc0 L_cs1_1
    v_dot2_f32_bf16 v244, v116, v236, v244
    v_dot2_f32_bf16 v245, v117, v236, v245
    v_dot2_f32_bf16 v244, v118, v236, v244
    v_dot2_f32_bf16 v245, v119, v236, v245
L_cs1_1:
    ds_read_b64_tr_b16 v[112:113], v14 offset:12288
    ds_read_b64_tr_b16 v[114:115], v14 offset:13312
    ds_read_b128 v[120:123], v9 offset:0
    ds_read_b64_tr_b16 v[116:117], v14 offset:28672
    ds_read_b64_tr_b16 v[118:119], v14 offset:29696
    ds_read_b128 v[124:127], v9 offset:4096
    s_waitcnt lgkmcnt(6)
    v_mfma_f32_32x32x16_bf16 v[32:47], v[96:99], v[104:107], v[32:47]
    s_add_u32 m0, s54, 131072
    s_nop 0
    buffer_load_dwordx4 v3, s[16:19], s7 offen lds
    v_mfma_f32_32x32x16_bf16 v[64:79], v[100:103], v[104:107], v[64:79]
    v_mfma_f32_32x32x16_bf16 v[48:63], v[96:99], v[108:111], v[48:63]
    buffer_load_dwordx4 v4, s[16:19], s7 offen offset:1024 lds
    v_mfma_f32_32x32x16_bf16 v[80:95], v[100:103], v[108:111], v[80:95]
    s_bitcmp1_b32 s60, 0
    s_cbranch_scc0 L_cs2_0
    v_dot2_f32_bf16 v244, v96, v236, v244
    v_dot2_f32_bf16 v245, v97, v236, v245
    v_dot2_f32_bf16 v244, v98, v236, v244
    v_dot2_f32_bf16 v245, v99, v236, v245
L_cs2_0:
    s_bitcmp1_b32 s60, 1
    s_cbranch_scc0 L_cs2_1
    v_dot2_f32_bf16 v244, v100, v236, v244
    v_dot2_f32_bf16 v245, v101, v236, v245
    v_dot2_f32_bf16 v244, v102, v236, v244
    v_dot2_f32_bf16 v245, v103, v236, v245
L_cs2_1:
    s_waitcnt vmcnt(6) lgkmcnt(0)
    s_barrier
    ds_read_b64_tr_b16 v[96:97], v15 offset:0
    ds_read_b64_tr_b16 v[98:99], v15 offset:1024
    ds_read_b128 v[104:107], v6 offset:49152
    ds_read_b64_tr_b16 v[100:101], v15 offset:16384
    ds_read_b64_tr_b16 v[102:103], v15 offset:17408
    ds_read_b128 v[108:111], v6 offset:53248
    v_mfma_f32_32x32x16_bf16 v[32:47], v[112:115], v[120:123], v[32:47]
    v_add_u32 v17, 1, v17
    s_xor_b32 s6, s50, 3
    s_mul_i32 s7, s6, 229376
    s_add_u32 s7, s7, s5
    s_lshl_b32 s6, s6, 7
    s_add_u32 m0, s54, 0
    s_add_u32 s6, s6, s4
    buffer_load_dwordx4 v1, s[8:11], s6 offen lds
    v_and_b32 v17, 0x0fff3fff, v17
    v_mfma_f32_32x32x16_bf16 v[64:79], v[116:119], v[120:123], v[64:79]
    buffer_load_dwordx4 v2, s[8:11], s6 offen offset:1024 lds
    v_or_b32 v17, 0x20000000, v17
    v_mfma_f32_32x32x16_bf16 v[48:63], v[112:115], v[124:127], v[48:63]
    ds_read_b64_tr_b16 v[208:209], v212
    s_mov_b32 s99, 0x3f803f80
    v_mfma_f32_32x32x16_bf16 v[80:95], v[116:119], v[124:127], v[80:95]
    ds_read_b64_tr_b16 v[210:211], v212 offset:512
    v_readfirstlane_b32 s53, v17
    s_bitcmp1_b32 s60, 0
    s_cbranch_scc0 L_cs3_0
    v_dot2_f32_bf16 v244, v112, v236, v244
    v_dot2_f32_bf16 v245, v113, v236, v245
    v_dot2_f32_bf16 v244, v114, v236, v244
    v_dot2_f32_bf16 v245, v115, v236, v245
L_cs3_0:
    s_bitcmp1_b32 s60, 1
    s_cbranch_scc0 L_cs3_1
    v_dot2_f32_bf16 v244, v116, v236, v244
    v_dot2_f32_bf16 v245, v117, v236, v245
    v_dot2_f32_bf16 v244, v118, v236, v244
    v_dot2_f32_bf16 v245, v119, v236, v245
L_cs3_1:
    ds_read_b64_tr_b16 v[112:113], v15 offset:4096
    ds_read_b64_tr_b16 v[114:115], v15 offset:5120
    ds_read_b128 v[120:123], v7 offset:49152
    ds_read_b64_tr_b16 v[116:117], v15 offset:20480
    ds_read_b64_tr_b16 v[118:119], v15 offset:21504
    ds_read_b128 v[124:127], v7 offset:53248
    s_waitcnt lgkmcnt(8)
    v_mfma_f32_32x32x16_bf16 v[32:47], v[96:99], v[104:107], v[32:47]
    v_dot2_f32_bf16 v204, v200, s99, 0
    s_add_u32 m0, s54, 16384
    s_nop 0
    buffer_load_dwordx4 v3, s[12:15], s7 offen lds
    v_dot2_f32_bf16 v205, v200, v200, 0
    v_mfma_f32_32x32x16_bf16 v[64:79], v[100:103], v[104:107], v[64:79]
    v_dot2_f32_bf16 v204, v201, s99, v204
    s_and_b32 s58, s3, 3
    s_lshl_b32 s58, s58, 10
    buffer_load_dwordx4 v[128:131], v5, s[32:35], s58 offen nt
    v_mfma_f32_32x32x16_bf16 v[48:63], v[96:99], v[108:111], v[48:63]
    v_dot2_f32_bf16 v205, v201, v201, v205
    v_dot2_f32_bf16 v204, v202, s99, v204
    v_mfma_f32_32x32x16_bf16 v[80:95], v[100:103], v[108:111], v[80:95]
    s_waitcnt lgkmcnt(6)
    buffer_store_dwordx4 v[208:211], v213, s[24:27], s44 offen sc1
    v_dot2_f32_bf16 v205, v202, v202, v205
    s_bitcmp1_b32 s60, 0
    s_cbranch_scc0 L_cs4_0
    v_dot2_f32_bf16 v244, v96, v236, v244
    v_dot2_f32_bf16 v245, v97, v236, v245
    v_dot2_f32_bf16 v244, v98, v236, v244
    v_dot2_f32_bf16 v245, v99, v236, v245
L_cs4_0:
    s_bitcmp1_b32 s60, 1
    s_cbranch_scc0 L_cs4_1
    v_dot2_f32_bf16 v244, v100, v236, v244
    v_dot2_f32_bf16 v245, v101, v236, v245
    v_dot2_f32_bf16 v244, v102, v236, v244
    v_dot2_f32_bf16 v245, v103, v236, v245
L_cs4_1:
    ds_read_b64_tr_b16 v[96:97], v15 offset:8192
    ds_read_b64_tr_b16 v[98:99], v15 offset:9216
    ds_read_b128 v[104:107], v8 offset:49152
    ds_read_b64_tr_b16 v[100:101], v15 offset:24576
    ds_read_b64_tr_b16 v[102:103], v15 offset:25600
    ds_read_b128 v[108:111], v8 offset:53248
    s_waitcnt lgkmcnt(6)
    v_mfma_f32_32x32x16_bf16 v[32:47], v[112:115], v[120:123], v[32:47]
    v_dot2_f32_bf16 v204, v203, s99, v204
    buffer_load_dwordx4 v4, s[12:15], s7 offen offset:1024 lds
    v_mfma_f32_32x32x16_bf16 v[64:79], v[116:119], v[120:123], v[64:79]
    v_dot2_f32_bf16 v205, v203, v203, v205
    v_mov_b32 v201, v17
    v_mfma_f32_32x32x16_bf16 v[48:63], v[112:115], v[124:127], v[48:63]
    s_nop 0
    v_permlane32_swap_b32 v204, v205
    s_add_u32 m0, s54, 32768
    s_nop 0
    buffer_load_dwordx4 v3, s[16:19], s7 offen lds
    v_mfma_f32_32x32x16_bf16 v[80:95], v[116:119], v[124:127], v[80:95]
    v_add_f32 v204, v204, v205
    s_nop 1
    v_add_f32_dpp v204, v204, v204 quad_perm:[1,0,3,2] row_mask:0xf bank_mask:0xf
    s_bitcmp1_b32 s60, 0
    s_cbranch_scc0 L_cs5_0
    v_dot2_f32_bf16 v244, v112, v236, v244
    v_dot2_f32_bf16 v245, v113, v236, v245
    v_dot2_f32_bf16 v244, v114, v236, v244
    v_dot2_f32_bf16 v245, v115, v236, v245
L_cs5_0:
    s_bitcmp1_b32 s60, 1
    s_cbranch_scc0 L_cs5_1
    v_dot2_f32_bf16 v244, v116, v236, v244
    v_dot2_f32_bf16 v245, v117, v236, v245
    v_dot2_f32_bf16 v244, v118, v236, v244
    v_dot2_f32_bf16 v245, v119, v236, v245
L_cs5_1:
    ds_read_b64_tr_b16 v[112:113], v15 offset:12288
    ds_read_b64_tr_b16 v[114:115], v15 offset:13312
    ds_read_b128 v[120:123], v9 offset:49152
    ds_read_b64_tr_b16 v[116:117], v15 offset:28672
    ds_read_b64_tr_b16 v[118:119], v15 offset:29696
    ds_read_b128 v[124:127], v9 offset:53248
    s_waitcnt lgkmcnt(6)
    v_mfma_f32_32x32x16_bf16 v[32:47], v[96:99], v[104:107], v[32:47]
    v_add_f32_dpp v204, v204, v204 quad_perm:[2,3,0,1] row_mask:0xf bank_mask:0xf
    buffer_load_dwordx4 v4, s[16:19], s7 offen offset:1024 lds
    v_mfma_f32_32x32x16_bf16 v[64:79], v[100:103], v[104:107], v[64:79]
    v_add_f32_dpp v204, v204, v204 row_half_mirror row_mask:0xf bank_mask:0xf
    s_nop 1
    v_add_f32_dpp v204, v204, v204 row_mirror row_mask:0xf bank_mask:0xf
    v_mfma_f32_32x32x16_bf16 v[48:63], v[96:99], v[108:111], v[48:63]
    s_nop 0
    v_add_f32_dpp v204, v204, v204 row_bcast:15 row_mask:0xa bank_mask:0xf
    v_mul_f32 v204, 0x3b000000, v204
    v_mfma_f32_32x32x16_bf16 v[80:95], v[100:103], v[108:111], v[80:95]
    v_readlane_b32 s99, v204, 31
    s_bitcmp1_b32 s60, 0
    s_cbranch_scc0 L_cs6_0
    v_dot2_f32_bf16 v244, v96, v236, v244
    v_dot2_f32_bf16 v245, v97, v236, v245
    v_dot2_f32_bf16 v244, v98, v236, v244
    v_dot2_f32_bf16 v245, v99, v236, v245
L_cs6_0:
    s_bitcmp1_b32 s60, 1
    s_cbranch_scc0 L_cs6_1
    v_dot2_f32_bf16 v244, v100, v236, v244
    v_dot2_f32_bf16 v245, v101, v236, v245
    v_dot2_f32_bf16 v244, v102, v236, v244
    v_dot2_f32_bf16 v245, v103, v236, v245
L_cs6_1:
    s_waitcnt vmcnt(8) lgkmcnt(0)
    s_barrier
    ds_read_b64_tr_b16 v[96:97], v16 offset:0
    ds_read_b64_tr_b16 v[98:99], v16 offset:1024
    ds_read_b128 v[104:107], v10 offset:0
    ds_read_b64_tr_b16 v[100:101], v16 offset:16384
    ds_read_b64_tr_b16 v[102:103], v16 offset:17408
    ds_read_b128 v[108:111], v10 offset:4096
    v_mfma_f32_32x32x16_bf16 v[32:47], v[112:115], v[120:123], v[32:47]
    v_readlane_b32 s100, v204, 63
    s_xor_b32 s6, s50, 4
    s_mul_i32 s7, s6, 229376
    s_add_u32 s7, s7, s5
    s_lshl_b32 s6, s6, 7
    s_add_u32 m0, s54, 49152
    s_add_u32 s6, s6, s4
    buffer_load_dwordx4 v1, s[8:11], s6 offen lds
    v_mfma_f32_32x32x16_bf16 v[64:79], v[116:119], v[120:123], v[64:79]
    v_mul_f32 v204, s99, s99
    v_sub_f32 v204, s100, v204
    v_mfma_f32_32x32x16_bf16 v[48:63], v[112:115], v[124:127], v[48:63]
    v_max_f32 v204, 0, v204
    buffer_load_dwordx4 v2, s[8:11], s6 offen offset:1024 lds
    v_mfma_f32_32x32x16_bf16 v[80:95], v[116:119], v[124:127], v[80:95]
    v_cvt_pk_bf16_f32 v204, v204, v204
    v_lshlrev_b32 v204, 16, v204
    s_bitcmp1_b32 s60, 0
    s_cbranch_scc0 L_cs7_0
    v_dot2_f32_bf16 v244, v112, v236, v244
    v_dot2_f32_bf16 v245, v113, v236, v245
    v_dot2_f32_bf16 v244, v114, v236, v244
    v_dot2_f32_bf16 v245, v115, v236, v245
L_cs7_0:
    s_bitcmp1_b32 s60, 1
    s_cbranch_scc0 L_cs7_1
    v_dot2_f32_bf16 v244, v116, v236, v244
    v_dot2_f32_bf16 v245, v117, v236, v245
    v_dot2_f32_bf16 v244, v118, v236, v244
    v_dot2_f32_bf16 v245, v119, v236, v245
L_cs7_1:
    ds_read_b64_tr_b16 v[112:113], v16 offset:4096
    ds_read_b64_tr_b16 v[114:115], v16 offset:5120
    ds_read_b128 v[120:123], v11 offset:0
    ds_read_b64_tr_b16 v[116:117], v16 offset:20480
    ds_read_b64_tr_b16 v[118:119], v16 offset:21504
    ds_read_b128 v[124:127], v11 offset:4096
    s_waitcnt lgkmcnt(6)
    v_mfma_f32_32x32x16_bf16 v[32:47], v[96:99], v[104:107], v[32:47]
    v_add_f32 v204, 0x3727c5ac, v204
    s_add_u32 m0, s54, 65536
    s_nop 0
    buffer_load_dwordx4 v3, s[12:15], s7 offen lds
    v_mfma_f32_32x32x16_bf16 v[64:79], v[100:103], v[104:107], v[64:79]
    v_cvt_pk_bf16_f32 v204, v204, v204
    v_lshlrev_b32 v204, 16, v204
    v_mfma_f32_32x32x16_bf16 v[48:63], v[96:99], v[108:111], v[48:63]
    v_sqrt_f32 v204, v204
    s_lshl_b32 s98, s98, 3
    v_mfma_f32_32x32x16_bf16 v[80:95], v[100:103], v[108:111], v[80:95]
    v_cvt_pk_bf16_f32 v200, v204, -s99
    s_add_u32 s98, s98, 32768
    ds_read_b64_tr_b16 v[96:97], v16 offset:8192
    ds_read_b64_tr_b16 v[98:99], v16 offset:9216
    ds_read_b128 v[104:107], v12 offset:0
    ds_read_b64_tr_b16 v[100:101], v16 offset:24576
    ds_read_b64_tr_b16 v[102:103], v16 offset:25600
    ds_read_b128 v[108:111], v12 offset:4096
    s_waitcnt lgkmcnt(6)
    v_mfma_f32_32x32x16_bf16 v[32:47], v[112:115], v[120:123], v[32:47]
    buffer_load_dwordx4 v4, s[12:15], s7 offen offset:1024 lds
    v_mfma_f32_32x32x16_bf16 v[64:79], v[116:119], v[120:123], v[64:79]
    s_lshl_b32 s46, s64, 2
    s_add_u32 s46, s46, s52
    s_lshl_b32 s46, s46, 10
    s_add_u32 s46, s46, 65536
    s_cmp_eq_u32 s60, 0
    s_cbranch_scc1 L_nocs
    v_add_f32 v240, v244, v245
    v_mov_b32 v244, v240
    s_nop 1
    v_permlane32_swap_b32 v244, v240
    s_nop 1
    v_add_f32 v240, v244, v240
    v_cvt_pk_bf16_f32 v241, v240, v240
    s_mul_i32 s58, s51, 57344
    v_lshlrev_b32 v241, 16, v241
    s_lshr_b32 s59, s50, 1
    v_sub_f32 v241, v240, v241
    s_lshl_b32 s59, s59, 3
    v_cvt_pk_bf16_f32 v240, v240, v241
    s_add_u32 s58, s58, s59
    v_mov_b32 v241, v17
    s_add_u32 s58, s58, s46
    v_lshlrev_b32 v242, 5, v0
    s_mov_b32 exec_hi, 0
    buffer_store_dwordx2 v[240:241], v242, s[24:27], s58 offen sc1
    s_mov_b32 exec_hi, -1
L_nocs:
    v_mfma_f32_32x32x16_bf16 v[48:63], v[112:115], v[124:127], v[48:63]
    s_add_u32 m0, s54, 81920
    s_nop 0
    buffer_load_dwordx4 v3, s[16:19], s7 offen lds
    v_mfma_f32_32x32x16_bf16 v[80:95], v[116:119], v[124:127], v[80:95]
    ds_read_b64_tr_b16 v[112:113], v16 offset:12288
    ds_read_b64_tr_b16 v[114:115], v16 offset:13312
    ds_read_b128 v[120:123], v13 offset:0
    ds_read_b64_tr_b16 v[116:117], v16 offset:28672
    ds_read_b64_tr_b16 v[118:119], v16 offset:29696
    ds_read_b128 v[124:127], v13 offset:4096
    s_waitcnt lgkmcnt(6)
    v_mfma_f32_32x32x16_bf16 v[32:47], v[96:99], v[104:107], v[32:47]
    buffer_load_dwordx4 v4, s[16:19], s7 offen offset:1024 lds
    v_mfma_f32_32x32x16_bf16 v[64:79], v[100:103], v[104:107], v[64:79]
    s_lshl_b32 s58, s49, 3
    s_add_u32 s58, s58, s3
    s_and_b32 s101, s49, 6
    s_lshl_b32 s101, s101, 1
    s_add_u32 s101, s101, s52
    s_lshl_b32 s101, s101, 1
    s_and_b32 s59, s49, 1
    s_add_u32 s101, s101, s59
    s_lshl_b32 s101, s101, 4
    s_add_u32 s101, s101, s51
    s_lshl_b32 s101, s101, 5
    s_add_u32 s101, s101, 32836
    s_mul_i32 s58, s58, 28672
    s_mul_i32 s59, s70, 12288
    s_add_u32 s58, s58, s59
    s_add_u32 s58, s58, 3145728
    s_lshl_b32 s59, s62, 10
    s_add_u32 s66, s58, s59
    s_xor_b32 s67, s66, 1024
    s_xor_b32 s68, s66, 2048
    s_xor_b32 s69, s66, 3072
    v_min_u32 v19, 27, v0
    v_and_b32 v18, 28, v19
    v_add_u32 v19, v19, v18
    v_lshlrev_b32 v19, 3, v19
    v_mfma_f32_32x32x16_bf16 v[48:63], v[96:99], v[108:111], v[48:63]
    s_waitcnt vmcnt(9)
    s_mov_b64 exec, 1
    buffer_store_dwordx2 v[200:201], off, s[24:27], s98 sc1
    s_mov_b64 exec, -1
    v_mfma_f32_32x32x16_bf16 v[80:95], v[100:103], v[108:111], v[80:95]
    s_waitcnt vmcnt(7) lgkmcnt(0)
    s_barrier
    ds_read_b64_tr_b16 v[96:97], v14 offset:0
    ds_read_b64_tr_b16 v[98:99], v14 offset:1024
    ds_read_b128 v[104:107], v6 offset:0
    ds_read_b64_tr_b16 v[100:101], v14 offset:16384
    ds_read_b64_tr_b16 v[102:103], v14 offset:17408
    ds_read_b128 v[108:111], v6 offset:4096
    v_mfma_f32_32x32x16_bf16 v[32:47], v[112:115], v[120:123], v[32:47]
    s_xor_b32 s6, s50, 5
    s_mul_i32 s7, s6, 229376
    s_add_u32 s7, s7, s5
    s_lshl_b32 s6, s6, 7
    s_add_u32 m0, s54, 98304
    s_add_u32 s6, s6, s4
    buffer_load_dwordx4 v1, s[8:11], s6 offen lds
    v_mfma_f32_32x32x16_bf16 v[64:79], v[116:119], v[120:123], v[64:79]
    v_mfma_f32_32x32x16_bf16 v[48:63], v[112:115], v[124:127], v[48:63]
    buffer_load_dwordx4 v2, s[8:11], s6 offen offset:1024 lds
    v_mfma_f32_32x32x16_bf16 v[80:95], v[116:119], v[124:127], v[80:95]
    ds_read_b64_tr_b16 v[112:113], v14 offset:4096
    ds_read_b64_tr_b16 v[114:115], v14 offset:5120
    ds_read_b128 v[120:123], v7 offset:0
    ds_read_b64_tr_b16 v[116:117], v14 offset:20480
    ds_read_b64_tr_b16 v[118:119], v14 offset:21504
    ds_read_b128 v[124:127], v7 offset:4096
    s_waitcnt lgkmcnt(6)
    v_mfma_f32_32x32x16_bf16 v[32:47], v[96:99], v[104:107], v[32:47]
    s_add_u32 m0, s54, 114688
    s_nop 0
    buffer_load_dwordx4 v3, s[12:15], s7 offen lds
    v_mfma_f32_32x32x16_bf16 v[64:79], v[100:103], v[104:107], v[64:79]
    v_mfma_f32_32x32x16_bf16 v[48:63], v[96:99], v[108:111], v[48:63]
    v_mfma_f32_32x32x16_bf16 v[80:95], v[100:103], v[108:111], v[80:95]
    ds_read_b64_tr_b16 v[96:97], v14 offset:8192
    ds_read_b64_tr_b16 v[98:99], v14 offset:9216
    ds_read_b128 v[104:107], v8 offset:0
    ds_read_b64_tr_b16 v[100:101], v14 offset:24576
    ds_read_b64_tr_b16 v[102:103], v14 offset:25600
    ds_read_b128 v[108:111], v8 offset:4096
    s_waitcnt lgkmcnt(6)
    v_mfma_f32_32x32x16_bf16 v[32:47], v[112:115], v[120:123], v[32:47]
    buffer_load_dwordx4 v4, s[12:15], s7 offen offset:1024 lds
    v_mfma_f32_32x32x16_bf16 v[64:79], v[116:119], v[120:123], v[64:79]
    v_mfma_f32_32x32x16_bf16 v[48:63], v[112:115], v[124:127], v[48:63]
    s_add_u32 m0, s54, 131072
    s_nop 0
    buffer_load_dwordx4 v3, s[16:19], s7 offen lds
    v_mfma_f32_32x32x16_bf16 v[80:95], v[116:119], v[124:127], v[80:95]
    ds_read_b64_tr_b16 v[112:113], v14 offset:12288
    ds_read_b64_tr_b16 v[114:115], v14 offset:13312
    ds_read_b128 v[120:123], v9 offset:0
    ds_read_b64_tr_b16 v[116:117], v14 offset:28672
    ds_read_b64_tr_b16 v[118:119], v14 offset:29696
    ds_read_b128 v[124:127], v9 offset:4096
    s_waitcnt lgkmcnt(6)
    v_mfma_f32_32x32x16_bf16 v[32:47], v[96:99], v[104:107], v[32:47]
    buffer_load_dwordx4 v4, s[16:19], s7 offen offset:1024 lds
    v_mfma_f32_32x32x16_bf16 v[64:79], v[100:103], v[104:107], v[64:79]
    v_mfma_f32_32x32x16_bf16 v[48:63], v[96:99], v[108:111], v[48:63]
    v_mfma_f32_32x32x16_bf16 v[80:95], v[100:103], v[108:111], v[80:95]
    s_waitcnt vmcnt(7) lgkmcnt(0)
    s_barrier
    ds_read_b64_tr_b16 v[96:97], v15 offset:0
    ds_read_b64_tr_b16 v[98:99], v15 offset:1024
    ds_read_b128 v[104:107], v6 offset:49152
    ds_read_b64_tr_b16 v[100:101], v15 offset:16384
    ds_read_b64_tr_b16 v[102:103], v15 offset:17408
    ds_read_b128 v[108:111], v6 offset:53248
    v_mfma_f32_32x32x16_bf16 v[32:47], v[112:115], v[120:123], v[32:47]
    s_xor_b32 s6, s50, 6
    s_mul_i32 s7, s6, 229376
    s_add_u32 s7, s7, s5
    s_lshl_b32 s6, s6, 7
    s_add_u32 m0, s54, 0
    s_add_u32 s6, s6, s4
    buffer_load_dwordx4 v1, s[8:11], s6 offen lds
    v_mfma_f32_32x32x16_bf16 v[64:79], v[116:119], v[120:123], v[64:79]
    v_mfma_f32_32x32x16_bf16 v[48:63], v[112:115], v[124:127], v[48:63]
    buffer_load_dwordx4 v2, s[8:11], s6 offen offset:1024 lds
    v_mfma_f32_32x32x16_bf16 v[80:95], v[116:119], v[124:127], v[80:95]
    ds_read_b64_tr_b16 v[112:113], v15 offset:4096
    ds_read_b64_tr_b16 v[114:115], v15 offset:5120
    ds_read_b128 v[120:123], v7 offset:49152
    ds_read_b64_tr_b16 v[116:117], v15 offset:20480
    ds_read_b64_tr_b16 v[118:119], v15 offset:21504
    ds_read_b128 v[124:127], v7 offset:53248
    s_waitcnt lgkmcnt(6)
    v_mfma_f32_32x32x16_bf16 v[32:47], v[96:99], v[104:107], v[32:47]
    s_add_u32 m0, s54, 16384
    s_nop 0
    buffer_load_dwordx4 v3, s[12:15], s7 offen lds
    v_mfma_f32_32x32x16_bf16 v[64:79], v[100:103], v[104:107], v[64:79]
    v_mfma_f32_32x32x16_bf16 v[48:63], v[96:99], v[108:111], v[48:63]
    v_mfma_f32_32x32x16_bf16 v[80:95], v[100:103], v[108:111], v[80:95]
    ds_read_b64_tr_b16 v[96:97], v15 offset:8192
    ds_read_b64_tr_b16 v[98:99], v15 offset:9216
    ds_read_b128 v[104:107], v8 offset:49152
    ds_read_b64_tr_b16 v[100:101], v15 offset:24576
    ds_read_b64_tr_b16 v[102:103], v15 offset:25600
    ds_read_b128 v[108:111], v8 offset:53248
    s_waitcnt lgkmcnt(6)
    v_mfma_f32_32x32x16_bf16 v[32:47], v[112:115], v[120:123], v[32:47]
    buffer_load_dwordx4 v4, s[12:15], s7 offen offset:1024 lds
    v_mfma_f32_32x32x16_bf16 v[64:79], v[116:119], v[120:123], v[64:79]
    v_mfma_f32_32x32x16_bf16 v[48:63], v[112:115], v[124:127], v[48:63]
    s_add_u32 m0, s54, 32768
    s_nop 0
    buffer_load_dwordx4 v3, s[16:19], s7 offen lds
    v_mfma_f32_32x32x16_bf16 v[80:95], v[116:119], v[124:127], v[80:95]
    ds_read_b64_tr_b16 v[112:113], v15 offset:12288
    ds_read_b64_tr_b16 v[114:115], v15 offset:13312
    ds_read_b128 v[120:123], v9 offset:49152
    ds_read_b64_tr_b16 v[116:117], v15 offset:28672
    ds_read_b64_tr_b16 v[118:119], v15 offset:29696
    ds_read_b128 v[124:127], v9 offset:53248
    s_waitcnt lgkmcnt(6)
    v_mfma_f32_32x32x16_bf16 v[32:47], v[96:99], v[104:107], v[32:47]
    v_and_b32 v29, 31, v0
    buffer_load_dwordx4 v4, s[16:19], s7 offen offset:1024 lds
    v_mfma_f32_32x32x16_bf16 v[64:79], v[100:103], v[104:107], v[64:79]
    v_lshlrev_b32 v29, 2, v29
    v_mfma_f32_32x32x16_bf16 v[48:63], v[96:99], v[108:111], v[48:63]
    s_lshl_b32 s100, s63, 7
    v_mfma_f32_32x32x16_bf16 v[80:95], v[100:103], v[108:111], v[80:95]
    s_add_u32 s100, s100, 4096
    s_waitcnt vmcnt(6) lgkmcnt(0)
    s_barrier
    ds_read_b64_tr_b16 v[96:97], v16 offset:0
    ds_read_b64_tr_b16 v[98:99], v16 offset:1024
    ds_read_b128 v[104:107], v10 offset:0
    ds_read_b64_tr_b16 v[100:101], v16 offset:16384
    ds_read_b64_tr_b16 v[102:103], v16 offset:17408
    ds_read_b128 v[108:111], v10 offset:4096
    v_mfma_f32_32x32x16_bf16 v[32:47], v[112:115], v[120:123], v[32:47]
    buffer_load_dword v18, v19, s[24:27], s101 offen sc1
    v_mfma_f32_32x32x16_bf16 v[64:79], v[116:119], v[120:123], v[64:79]
    s_xor_b32 s6, s50, 7
    s_mul_i32 s7, s6, 229376
    s_add_u32 s7, s7, s5
    s_lshl_b32 s6, s6, 7
    s_add_u32 m0, s54, 49152
    s_add_u32 s6, s6, s4
    buffer_load_dwordx4 v1, s[8:11], s6 offen lds
    v_mfma_f32_32x32x16_bf16 v[48:63], v[112:115], v[124:127], v[48:63]
    buffer_load_dwordx4 v2, s[8:11], s6 offen offset:1024 lds
    v_mfma_f32_32x32x16_bf16 v[80:95], v[116:119], v[124:127], v[80:95]
    ds_read_b64_tr_b16 v[112:113], v16 offset:4096
    ds_read_b64_tr_b16 v[114:115], v16 offset:5120
    ds_read_b128 v[120:123], v11 offset:0
    ds_read_b64_tr_b16 v[116:117], v16 offset:20480
    ds_read_b64_tr_b16 v[118:119], v16 offset:21504
    ds_read_b128 v[124:127], v11 offset:4096
    s_waitcnt lgkmcnt(6)
    v_mfma_f32_32x32x16_bf16 v[32:47], v[96:99], v[104:107], v[32:47]
    s_and_b32 s58, s3, 3
    s_cselect_b32 s58, s55, 0
    v_mov_b32 v132, s58
    v_mfma_f32_32x32x16_bf16 v[64:79], v[100:103], v[104:107], v[64:79]
    s_add_u32 m0, s54, 65536
    s_nop 0
    buffer_load_dwordx4 v3, s[12:15], s7 offen lds
    v_mfma_f32_32x32x16_bf16 v[48:63], v[96:99], v[108:111], v[48:63]
    v_alignbit_b32 v135, v129, v128, 16
    v_mfma_f32_32x32x16_bf16 v[80:95], v[100:103], v[108:111], v[80:95]
    v_alignbit_b32 v136, v130, v129, 16
    ds_read_b64_tr_b16 v[96:97], v16 offset:8192
    ds_read_b64_tr_b16 v[98:99], v16 offset:9216
    ds_read_b128 v[104:107], v12 offset:0
    ds_read_b64_tr_b16 v[100:101], v16 offset:24576
    ds_read_b64_tr_b16 v[102:103], v16 offset:25600
    ds_read_b128 v[108:111], v12 offset:4096
    s_waitcnt lgkmcnt(6)
    v_mfma_f32_32x32x16_bf16 v[32:47], v[112:115], v[120:123], v[32:47]
    v_alignbit_b32 v137, v131, v130, 16
    buffer_load_dwordx4 v4, s[12:15], s7 offen offset:1024 lds
    v_mfma_f32_32x32x16_bf16 v[64:79], v[116:119], v[120:123], v[64:79]
    v_mov_b32_dpp v132, v131 wave_shr:1 row_mask:0xf bank_mask:0xf
    v_mfma_f32_32x32x16_bf16 v[48:63], v[112:115], v[124:127], v[48:63]
    v_mov_b32 v140, 0
    s_add_u32 m0, s54, 81920
    s_nop 0
    buffer_load_dwordx4 v3, s[16:19], s7 offen lds
    v_mfma_f32_32x32x16_bf16 v[80:95], v[116:119], v[124:127], v[80:95]
    v_mov_b32 v141, 0
    ds_read_b64_tr_b16 v[112:113], v16 offset:12288
    ds_read_b64_tr_b16 v[114:115], v16 offset:13312
    ds_read_b128 v[120:123], v13 offset:0
    ds_read_b64_tr_b16 v[116:117], v16 offset:28672
    ds_read_b64_tr_b16 v[118:119], v16 offset:29696
    ds_read_b128 v[124:127], v13 offset:4096
    s_waitcnt lgkmcnt(6)
    v_mfma_f32_32x32x16_bf16 v[32:47], v[96:99], v[104:107], v[32:47]
    s_waitcnt vmcnt(5)
    v_cmp_ne_u32 vcc, s53, v18
    s_cmp_lg_u64 vcc, 0
    s_cbranch_scc0 L_fw_ok
    s_mov_b32 s57, 16384
L_fw_loop:
    buffer_load_dword v18, v19, s[24:27], s101 offen sc1
    s_waitcnt vmcnt(0)
    v_cmp_ne_u32 vcc, s53, v18
    s_cmp_lg_u64 vcc, 0
    s_cbranch_scc0 L_fw_ok
    s_sub_u32 s57, s57, 1
    s_cbranch_scc0 L_fw_loop
L_fw_ok:
    v_mov_b32 v142, 0
    v_mfma_f32_32x32x16_bf16 v[64:79], v[100:103], v[104:107], v[64:79]
    buffer_load_dwordx4 v4, s[16:19], s7 offen offset:1024 lds
    v_mov_b32 v143, 0
    v_mfma_f32_32x32x16_bf16 v[48:63], v[96:99], v[108:111], v[48:63]
    v_alignbit_b32 v134, v128, v132, 16
    s_add_u32 s59, s66, 0
    buffer_load_dwordx4 v[144:147], v5, s[24:27], s59 offen sc1
    v_mfma_f32_32x32x16_bf16 v[80:95], v[100:103], v[108:111], v[80:95]
    s_lshr_b32 s58, s3, 2
    s_mul_i32 s58, s58, 12864
    s_add_u32 s58, s58, 98304
    v_min_u32 v133, 35, v0
    v_lshlrev_b32 v133, 4, v133
    v_lshrrev_b32 v132, 5, v0
    v_lshl_add_u32 v133, v132, 12, v133
    v_add_u32 v133, s58, v133
    s_and_b32 s59, s3, 3
    s_lshl_b32 s59, s59, 10
    s_add_u32 s58, s58, s59
    v_add_u32 v132, s58, v5
    s_waitcnt lgkmcnt(0)
    s_barrier
    ds_read_b64_tr_b16 v[96:97], v14 offset:0
    ds_read_b64_tr_b16 v[98:99], v14 offset:1024
    ds_read_b128 v[104:107], v6 offset:0
    ds_read_b64_tr_b16 v[100:101], v14 offset:16384
    ds_read_b64_tr_b16 v[102:103], v14 offset:17408
    ds_read_b128 v[108:111], v6 offset:4096
    v_mfma_f32_32x32x16_bf16 v[32:47], v[112:115], v[120:123], v[32:47]
    ds_write_b128 v132, v[128:131] offset:4608
    v_mfma_f32_32x32x16_bf16 v[64:79], v[116:119], v[120:123], v[64:79]
    v_mfma_f32_32x32x16_bf16 v[48:63], v[112:115], v[124:127], v[48:63]
    s_add_u32 s59, s67, 0
    buffer_load_dwordx4 v[148:151], v5, s[24:27], s59 offen sc1
    v_mfma_f32_32x32x16_bf16 v[80:95], v[116:119], v[124:127], v[80:95]
    ds_read_b64_tr_b16 v[112:113], v14 offset:4096
    ds_read_b64_tr_b16 v[114:115], v14 offset:5120
    ds_read_b128 v[120:123], v7 offset:0
    ds_read_b64_tr_b16 v[116:117], v14 offset:20480
    ds_read_b64_tr_b16 v[118:119], v14 offset:21504
    ds_read_b128 v[124:127], v7 offset:4096
    s_waitcnt lgkmcnt(7)
    v_mfma_f32_32x32x16_bf16 v[32:47], v[96:99], v[104:107], v[32:47]
    s_add_u32 s59, s68, 0
    buffer_load_dwordx4 v[152:155], v5, s[24:27], s59 offen sc1
    v_mfma_f32_32x32x16_bf16 v[64:79], v[100:103], v[104:107], v[64:79]
    ds_write_b128 v132, v[134:137] offset:8768
    v_mfma_f32_32x32x16_bf16 v[48:63], v[96:99], v[108:111], v[48:63]
    s_add_u32 s59, s69, 0
    buffer_load_dwordx4 v[156:159], v5, s[24:27], s59 offen sc1
    v_mfma_f32_32x32x16_bf16 v[80:95], v[100:103], v[108:111], v[80:95]
    ds_read_b64_tr_b16 v[96:97], v14 offset:8192
    ds_read_b64_tr_b16 v[98:99], v14 offset:9216
    ds_read_b128 v[104:107], v8 offset:0
    ds_read_b64_tr_b16 v[100:101], v14 offset:24576
    ds_read_b64_tr_b16 v[102:103], v14 offset:25600
    ds_read_b128 v[108:111], v8 offset:4096
    s_waitcnt lgkmcnt(7)
    v_mfma_f32_32x32x16_bf16 v[32:47], v[112:115], v[120:123], v[32:47]
    s_add_u32 s59, s66, 4096
    buffer_load_dwordx4 v[160:163], v5, s[24:27], s59 offen sc1
    v_mfma_f32_32x32x16_bf16 v[64:79], v[116:119], v[120:123], v[64:79]
    ds_write_b128 v133, v[140:143] offset:4096
    v_mfma_f32_32x32x16_bf16 v[48:63], v[112:115], v[124:127], v[48:63]
    s_add_u32 s59, s67, 4096
    buffer_load_dwordx4 v[164:167], v5, s[24:27], s59 offen sc1
    v_mfma_f32_32x32x16_bf16 v[80:95], v[116:119], v[124:127], v[80:95]
    ds_read_b64_tr_b16 v[112:113], v14 offset:12288
    ds_read_b64_tr_b16 v[114:115], v14 offset:13312
    ds_read_b128 v[120:123], v9 offset:0
    ds_read_b64_tr_b16 v[116:117], v14 offset:28672
    ds_read_b64_tr_b16 v[118:119], v14 offset:29696
    ds_read_b128 v[124:127], v9 offset:4096
    s_waitcnt lgkmcnt(7)
    v_mfma_f32_32x32x16_bf16 v[32:47], v[96:99], v[104:107], v[32:47]
    v_and_b32 v24, 31, v0
    s_add_u32 s59, s68, 4096
    buffer_load_dwordx4 v[168:171], v5, s[24:27], s59 offen sc1
    v_lshrrev_b32 v25, 5, v0
    v_lshlrev_b32 v25, 4, v25
    v_mfma_f32_32x32x16_bf16 v[64:79], v[100:103], v[104:107], v[64:79]
    v_lshl_add_u32 v1, v24, 5, v25
    v_and_b32 v24, 15, v0
    v_lshrrev_b32 v25, 4, v0
    v_lshlrev_b32 v25, 3, v25
    v_mfma_f32_32x32x16_bf16 v[48:63], v[96:99], v[108:111], v[48:63]
    s_add_u32 s59, s69, 4096
    buffer_load_dwordx4 v[172:175], v5, s[24:27], s59 offen sc1
    v_lshl_add_u32 v2, v24, 5, v25
    s_lshl_b32 s50, s71, 1
    s_add_u32 s50, s50, s51
    v_mfma_f32_32x32x16_bf16 v[80:95], v[100:103], v[108:111], v[80:95]
    s_lshl_b32 s5, s50, 9
    s_add_u32 s5, s5, 32768
    s_add_u32 s4, s46, 57344
    s_waitcnt vmcnt(8) lgkmcnt(0)
    s_barrier
    ds_read_b64_tr_b16 v[96:97], v15 offset:0
    ds_read_b64_tr_b16 v[98:99], v15 offset:1024
    ds_read_b128 v[104:107], v6 offset:49152
    ds_read_b64_tr_b16 v[100:101], v15 offset:16384
    ds_read_b64_tr_b16 v[102:103], v15 offset:17408
    ds_read_b128 v[108:111], v6 offset:53248
    v_mfma_f32_32x32x16_bf16 v[32:47], v[112:115], v[120:123], v[32:47]
    buffer_load_dword v30, v29, s[24:27], s100 offen sc1
    v_mfma_f32_32x32x16_bf16 v[64:79], v[116:119], v[120:123], v[64:79]
    buffer_load_dwordx4 v[128:131], v1, s[24:27], s46 offen sc1
    v_mfma_f32_32x32x16_bf16 v[48:63], v[112:115], v[124:127], v[48:63]
    buffer_load_dwordx4 v[132:135], v1, s[24:27], s4 offen sc1
    v_mfma_f32_32x32x16_bf16 v[80:95], v[116:119], v[124:127], v[80:95]
    buffer_load_dwordx2 v[20:21], v2, s[24:27], s5 offen sc1
    ds_read_b64_tr_b16 v[112:113], v15 offset:4096
    ds_read_b64_tr_b16 v[114:115], v15 offset:5120
    ds_read_b128 v[120:123], v7 offset:49152
    ds_read_b64_tr_b16 v[116:117], v15 offset:20480
    ds_read_b64_tr_b16 v[118:119], v15 offset:21504
    ds_read_b128 v[124:127], v7 offset:53248
    s_waitcnt lgkmcnt(6)
    v_mfma_f32_32x32x16_bf16 v[32:47], v[96:99], v[104:107], v[32:47]
    s_add_u32 s59, s66, 8192
    buffer_load_dwordx4 v[176:179], v5, s[24:27], s59 offen sc1
    v_mfma_f32_32x32x16_bf16 v[64:79], v[100:103], v[104:107], v[64:79]
    v_mfma_f32_32x32x16_bf16 v[48:63], v[96:99], v[108:111], v[48:63]
    v_mfma_f32_32x32x16_bf16 v[80:95], v[100:103], v[108:111], v[80:95]
    ds_read_b64_tr_b16 v[96:97], v15 offset:8192
    ds_read_b64_tr_b16 v[98:99], v15 offset:9216
    ds_read_b128 v[104:107], v8 offset:49152
    ds_read_b64_tr_b16 v[100:101], v15 offset:24576
    ds_read_b64_tr_b16 v[102:103], v15 offset:25600
    ds_read_b128 v[108:111], v8 offset:53248
    s_waitcnt lgkmcnt(6)
    v_mfma_f32_32x32x16_bf16 v[32:47], v[112:115], v[120:123], v[32:47]
    v_mov_b32 v137, 0
    s_add_u32 s59, s67, 8192
    buffer_load_dwordx4 v[180:183], v5, s[24:27], s59 offen sc1
    v_mfma_f32_32x32x16_bf16 v[64:79], v[116:119], v[120:123], v[64:79]
    v_mov_b32 v139, 0
    v_mov_b32 v141, 0
    v_mfma_f32_32x32x16_bf16 v[48:63], v[112:115], v[124:127], v[48:63]
    s_add_u32 s59, s68, 8192
    buffer_load_dwordx4 v[184:187], v5, s[24:27], s59 offen sc1
    v_mov_b32 v143, 0
    v_mfma_f32_32x32x16_bf16 v[80:95], v[116:119], v[124:127], v[80:95]
    s_mov_b32 s99, 0x03020302
    ds_read_b64_tr_b16 v[112:113], v15 offset:12288
    ds_read_b64_tr_b16 v[114:115], v15 offset:13312
    ds_read_b128 v[120:123], v9 offset:49152
    ds_read_b64_tr_b16 v[116:117], v15 offset:28672
    ds_read_b64_tr_b16 v[118:119], v15 offset:29696
    ds_read_b128 v[124:127], v9 offset:53248
    s_waitcnt lgkmcnt(6)
    v_mfma_f32_32x32x16_bf16 v[32:47], v[96:99], v[104:107], v[32:47]
    s_add_u32 s59, s69, 8192
    buffer_load_dwordx4 v[188:191], v5, s[24:27], s59 offen sc1
    v_mfma_f32_32x32x16_bf16 v[64:79], v[100:103], v[104:107], v[64:79]
    v_mfma_f32_32x32x16_bf16 v[48:63], v[96:99], v[108:111], v[48:63]
    s_add_u32 s59, s66, 12288
    buffer_load_dwordx4 v[192:195], v5, s[24:27], s59 offen sc1
    v_mfma_f32_32x32x16_bf16 v[80:95], v[100:103], v[108:111], v[80:95]
    s_waitcnt vmcnt(5)
    v_min3_u32 v24, v129, v131, v21
    v_max3_u32 v25, v129, v131, v21
    v_min3_u32 v24, v24, v133, v135
    v_max3_u32 v25, v25, v133, v135
    v_cmp_ne_u32 vcc, s53, v24
    v_cmp_ne_u32 s[6:7], s53, v25
    s_or_b64 vcc, vcc, s[6:7]
    s_cbranch_scc0 L_ex_ok
    s_mov_b32 s57, 16384
L_ex_loop:
    buffer_load_dwordx4 v[128:131], v1, s[24:27], s46 offen sc1
    buffer_load_dwordx4 v[132:135], v1, s[24:27], s4 offen sc1
    buffer_load_dwordx2 v[20:21], v2, s[24:27], s5 offen sc1
    s_waitcnt vmcnt(0)
    v_min3_u32 v24, v129, v131, v21
    v_max3_u32 v25, v129, v131, v21
    v_min3_u32 v24, v24, v133, v135
    v_max3_u32 v25, v25, v133, v135
    v_cmp_ne_u32 vcc, s53, v24
    v_cmp_ne_u32 s[6:7], s53, v25
    s_or_b64 vcc, vcc, s[6:7]
    s_cbranch_scc0 L_ex_ok
    s_sub_u32 s57, s57, 1
    s_cbranch_scc0 L_ex_loop
L_ex_ok:
    s_waitcnt lgkmcnt(0)
    v_mfma_f32_32x32x16_bf16 v[32:47], v[112:115], v[120:123], v[32:47]
    v_mov_b32 v21, v20
    v_cmp_ne_u32 vcc, s53, v30
    s_cmp_lg_u64 vcc, 0
    s_cselect_b32 s55, 0, 1
    s_cselect_b64 vcc, 0, -1
    s_lshr_b32 s58, s3, 2
    s_mul_i32 s59, s58, 8768
    s_lshl_b32 s58, s58, 4
    v_lshl_add_u32 v24, v0, 5, s58
    s_lshl_b32 s58, s3, 10
    s_add_u32 s59, s59, s58
    s_add_u32 m0, s59, 98304
    s_and_b32 s58, s54, 0x1800
    s_lshl_b32 s59, s61, 13
    s_add_u32 s58, s58, s59
    s_add_u32 s58, s58, 1048576
    s_mov_b64 exec, vcc
    buffer_load_dwordx4 v24, s[24:27], s58 offen sc1 lds
    s_mov_b64 exec, -1
    v_permlane32_swap_b32 v20, v21
    v_mfma_f32_32x32x16_bf16 v[64:79], v[116:119], v[120:123], v[64:79]
    v_perm_b32 v136, v20, v20, s99
    v_perm_b32 v138, v20, v20, s99
    v_mfma_f32_32x32x16_bf16 v[48:63], v[112:115], v[124:127], v[48:63]
    v_perm_b32 v140, v21, v21, s99
    v_perm_b32 v142, v21, v21, s99
    v_mfma_f32_32x32x16_bf16 v[80:95], v[116:119], v[124:127], v[80:95]
    v_lshlrev_b32 v20, 16, v20
    v_lshlrev_b32 v21, 16, v21
    v_mfma_f32_32x32x16_bf16 v[32:47], v[128:131], v[136:139], v[32:47]
    v_rcp_f32 v96, v20
    v_mul_f32 v116, v20, v20
    v_mul_f32 v117, v20, v20
    v_rcp_f32 v97, v21
    v_mul_f32 v122, v21, v21
    v_mul_f32 v123, v21, v21
    v_mul_f32 v112, 0xc0135761, v96
    v_mul_f32 v113, 0xc0135761, v96
    v_mul_f32 v96, v96, v96
    v_mfma_f32_32x32x16_bf16 v[64:79], v[132:135], v[136:139], v[64:79]
    v_mul_f32 v96, 0x3d372713, v96
    v_mul_f32 v114, v112, v96
    v_mul_f32 v115, v112, v96
    v_mul_f32 v118, 0xc0135761, v97
    v_mul_f32 v119, 0xc0135761, v97
    v_mul_f32 v97, v97, v97
    v_mul_f32 v97, 0x3d372713, v97
    v_mul_f32 v120, v118, v97
    v_mfma_f32_32x32x16_bf16 v[48:63], v[128:131], v[140:143], v[48:63]
    v_mul_f32 v121, v118, v97
    v_bfe_u32 v104, v0, 4, 1
    v_mul_u32_u24 v104, 57344, v104
    v_and_b32 v105, 15, v0
    v_lshl_add_u32 v104, v105, 4, v104
    v_lshrrev_b32 v105, 5, v0
    v_lshl_add_u32 v28, v105, 8, v104
    s_mul_i32 s4, s50, 229376
    v_mfma_f32_32x32x16_bf16 v[80:95], v[132:135], v[140:143], v[80:95]
    s_add_u32 s4, s4, s46
    s_add_u32 s4, s4, 8323072
    s_add_u32 s5, s4, 114688
    s_sub_u32 s36, s46, 65536
    s_lshr_b32 s36, s36, 3
    s_mul_i32 s6, s50, 7168
    s_add_u32 s36, s36, s6
    s_add_u32 s36, s36, 262144
    v_pk_mul_f32 v[96:97], v[32:33], v[32:33]
    s_add_u32 s59, s67, 12288
    buffer_load_dwordx4 v[196:199], v5, s[24:27], s59 offen sc1
    v_pk_mul_f32 v[98:99], v[34:35], v[34:35]
    v_pk_mul_f32 v[100:101], v[36:37], v[36:37]
    v_pk_mul_f32 v[102:103], v[38:39], v[38:39]
    v_pk_fma_f32 v[96:97], v[96:97], v[114:115], v[112:113]
    v_pk_fma_f32 v[98:99], v[98:99], v[114:115], v[112:113]
    v_pk_fma_f32 v[100:101], v[100:101], v[114:115], v[112:113]
    v_pk_fma_f32 v[102:103], v[102:103], v[114:115], v[112:113]
    v_pk_mul_f32 v[96:97], v[96:97], v[32:33]
    v_pk_mul_f32 v[98:99], v[98:99], v[34:35]
    v_pk_mul_f32 v[100:101], v[100:101], v[36:37]
    v_pk_mul_f32 v[102:103], v[102:103], v[38:39]
    v_exp_f32 v96, v96
    v_pk_mul_f32 v[64:65], v[64:65], v[32:33]
    v_exp_f32 v97, v97
    s_add_u32 s59, s68, 12288
    buffer_load_dwordx4 v[200:203], v5, s[24:27], s59 offen sc1
    v_exp_f32 v98, v98
    v_pk_mul_f32 v[66:67], v[66:67], v[34:35]
    v_exp_f32 v99, v99
    v_exp_f32 v100, v100
    v_pk_mul_f32 v[68:69], v[68:69], v[36:37]
    v_exp_f32 v101, v101
    v_exp_f32 v102, v102
    v_pk_mul_f32 v[70:71], v[70:71], v[38:39]
    v_exp_f32 v103, v103
    v_pk_fma_f32 v[96:97], v[96:97], v[116:117], v[116:117]
    v_pk_fma_f32 v[98:99], v[98:99], v[116:117], v[116:117]
    v_pk_fma_f32 v[100:101], v[100:101], v[116:117], v[116:117]
    v_pk_fma_f32 v[102:103], v[102:103], v[116:117], v[116:117]
    v_rcp_f32 v96, v96
    v_rcp_f32 v97, v97
    s_add_u32 s59, s69, 12288
    buffer_load_dwordx4 v[204:207], v5, s[24:27], s59 offen sc1
    v_rcp_f32 v98, v98
    v_rcp_f32 v99, v99
    v_rcp_f32 v100, v100
    v_rcp_f32 v101, v101
    v_rcp_f32 v102, v102
    v_rcp_f32 v103, v103
    v_pk_mul_f32 v[64:65], v[64:65], v[96:97]
    v_pk_mul_f32 v[66:67], v[66:67], v[98:99]
    v_pk_mul_f32 v[68:69], v[68:69], v[100:101]
    v_pk_mul_f32 v[70:71], v[70:71], v[102:103]
    v_cvt_pk_bf16_f32 v104, v64, v65
    v_cvt_pk_bf16_f32 v105, v66, v67
    v_cvt_pk_bf16_f32 v106, v68, v69
    v_cvt_pk_bf16_f32 v107, v70, v71
    buffer_store_dwordx4 v[104:107], v28, s[24:27], s4 offen offset:0 sc1
    v_pk_mul_f32 v[96:97], v[40:41], v[40:41]
    s_mul_i32 s59, s70, 28672
    s_sub_u32 s66, s66, s59
    s_sub_u32 s67, s67, s59
    s_sub_u32 s68, s68, s59
    s_sub_u32 s69, s69, s59
    s_add_u32 s59, s66, 16384
    buffer_load_dwordx4 v[208:211], v5, s[24:27], s59 offen sc1
    v_pk_mul_f32 v[98:99], v[42:43], v[42:43]
    v_pk_mul_f32 v[100:101], v[44:45], v[44:45]
    v_pk_mul_f32 v[102:103], v[46:47], v[46:47]
    v_pk_fma_f32 v[96:97], v[96:97], v[114:115], v[112:113]
    v_pk_fma_f32 v[98:99], v[98:99], v[114:115], v[112:113]
    v_pk_fma_f32 v[100:101], v[100:101], v[114:115], v[112:113]
    v_pk_fma_f32 v[102:103], v[102:103], v[114:115], v[112:113]
    v_pk_mul_f32 v[96:97], v[96:97], v[40:41]
    v_pk_mul_f32 v[98:99], v[98:99], v[42:43]
    v_pk_mul_f32 v[100:101], v[100:101], v[44:45]
    v_pk_mul_f32 v[102:103], v[102:103], v[46:47]
    v_exp_f32 v96, v96
    v_pk_mul_f32 v[72:73], v[72:73], v[40:41]
    v_exp_f32 v97, v97
    s_add_u32 s59, s67, 16384
    buffer_load_dwordx4 v[212:215], v5, s[24:27], s59 offen sc1
    v_exp_f32 v98, v98
    v_pk_mul_f32 v[74:75], v[74:75], v[42:43]
    v_exp_f32 v99, v99
    v_exp_f32 v100, v100
    v_pk_mul_f32 v[76:77], v[76:77], v[44:45]
    v_exp_f32 v101, v101
    v_exp_f32 v102, v102
    v_pk_mul_f32 v[78:79], v[78:79], v[46:47]
    v_exp_f32 v103, v103
    v_pk_fma_f32 v[96:97], v[96:97], v[116:117], v[116:117]
    v_pk_fma_f32 v[98:99], v[98:99], v[116:117], v[116:117]
    v_pk_fma_f32 v[100:101], v[100:101], v[116:117], v[116:117]
    v_pk_fma_f32 v[102:103], v[102:103], v[116:117], v[116:117]
    v_rcp_f32 v96, v96
    v_rcp_f32 v97, v97
    s_add_u32 s59, s68, 16384
    buffer_load_dwordx4 v[216:219], v5, s[24:27], s59 offen sc1
    v_rcp_f32 v98, v98
    v_rcp_f32 v99, v99
    v_rcp_f32 v100, v100
    v_rcp_f32 v101, v101
    v_rcp_f32 v102, v102
    v_rcp_f32 v103, v103
    v_pk_mul_f32 v[72:73], v[72:73], v[96:97]
    v_pk_mul_f32 v[74:75], v[74:75], v[98:99]
    v_pk_mul_f32 v[76:77], v[76:77], v[100:101]
    v_pk_mul_f32 v[78:79], v[78:79], v[102:103]
    v_cvt_pk_bf16_f32 v108, v72, v73
    v_cvt_pk_bf16_f32 v109, v74, v75
    v_cvt_pk_bf16_f32 v110, v76, v77
    v_cvt_pk_bf16_f32 v111, v78, v79
    buffer_store_dwordx4 v[108:111], v28, s[24:27], s4 offen offset:512 sc1
    v_pk_mul_f32 v[96:97], v[48:49], v[48:49]
    s_add_u32 s59, s69, 16384
    buffer_load_dwordx4 v[220:223], v5, s[24:27], s59 offen sc1
    v_pk_mul_f32 v[98:99], v[50:51], v[50:51]
    v_pk_mul_f32 v[100:101], v[52:53], v[52:53]
    v_pk_mul_f32 v[102:103], v[54:55], v[54:55]
    v_pk_fma_f32 v[96:97], v[96:97], v[120:121], v[118:119]
    v_pk_fma_f32 v[98:99], v[98:99], v[120:121], v[118:119]
    v_pk_fma_f32 v[100:101], v[100:101], v[120:121], v[118:119]
    v_pk_fma_f32 v[102:103], v[102:103], v[120:121], v[118:119]
    v_pk_mul_f32 v[96:97], v[96:97], v[48:49]
    v_pk_mul_f32 v[98:99], v[98:99], v[50:51]
    v_pk_mul_f32 v[100:101], v[100:101], v[52:53]
    v_pk_mul_f32 v[102:103], v[102:103], v[54:55]
    v_exp_f32 v96, v96
    v_pk_mul_f32 v[80:81], v[80:81], v[48:49]
    v_exp_f32 v97, v97
    v_exp_f32 v98, v98
    v_pk_mul_f32 v[82:83], v[82:83], v[50:51]
    v_exp_f32 v99, v99
    v_exp_f32 v100, v100
    v_pk_mul_f32 v[84:85], v[84:85], v[52:53]
    v_exp_f32 v101, v101
    v_exp_f32 v102, v102
    v_pk_mul_f32 v[86:87], v[86:87], v[54:55]
    s_add_u32 s59, s66, 20480
    buffer_load_dwordx4 v[224:227], v5, s[24:27], s59 offen sc1
    v_exp_f32 v103, v103
    v_pk_fma_f32 v[96:97], v[96:97], v[122:123], v[122:123]
    v_pk_fma_f32 v[98:99], v[98:99], v[122:123], v[122:123]
    v_pk_fma_f32 v[100:101], v[100:101], v[122:123], v[122:123]
    v_pk_fma_f32 v[102:103], v[102:103], v[122:123], v[122:123]
    v_rcp_f32 v96, v96
    v_rcp_f32 v97, v97
    v_rcp_f32 v98, v98
    v_rcp_f32 v99, v99
    v_rcp_f32 v100, v100
    v_rcp_f32 v101, v101
    v_rcp_f32 v102, v102
    v_rcp_f32 v103, v103
    v_pk_mul_f32 v[80:81], v[80:81], v[96:97]
    v_pk_mul_f32 v[82:83], v[82:83], v[98:99]
    v_pk_mul_f32 v[84:85], v[84:85], v[100:101]
    v_pk_mul_f32 v[86:87], v[86:87], v[102:103]
    v_cvt_pk_bf16_f32 v104, v80, v81
    v_cvt_pk_bf16_f32 v105, v82, v83
    v_cvt_pk_bf16_f32 v106, v84, v85
    v_cvt_pk_bf16_f32 v107, v86, v87
    buffer_store_dwordx4 v[104:107], v28, s[24:27], s5 offen offset:0 sc1
    v_pk_mul_f32 v[96:97], v[56:57], v[56:57]
    v_pk_mul_f32 v[98:99], v[58:59], v[58:59]
    v_pk_mul_f32 v[100:101], v[60:61], v[60:61]
    v_pk_mul_f32 v[102:103], v[62:63], v[62:63]
    v_pk_fma_f32 v[96:97], v[96:97], v[120:121], v[118:119]
    v_pk_fma_f32 v[98:99], v[98:99], v[120:121], v[118:119]
    v_pk_fma_f32 v[100:101], v[100:101], v[120:121], v[118:119]
    v_pk_fma_f32 v[102:103], v[102:103], v[120:121], v[118:119]
    v_pk_mul_f32 v[96:97], v[96:97], v[56:57]
    v_pk_mul_f32 v[98:99], v[98:99], v[58:59]
    v_pk_mul_f32 v[100:101], v[100:101], v[60:61]
    v_pk_mul_f32 v[102:103], v[102:103], v[62:63]
    v_exp_f32 v96, v96
    v_pk_mul_f32 v[88:89], v[88:89], v[56:57]
    v_exp_f32 v97, v97
    v_exp_f32 v98, v98
    v_pk_mul_f32 v[90:91], v[90:91], v[58:59]
    v_exp_f32 v99, v99
    v_exp_f32 v100, v100
    v_pk_mul_f32 v[92:93], v[92:93], v[60:61]
    v_exp_f32 v101, v101
    v_exp_f32 v102, v102
    v_pk_mul_f32 v[94:95], v[94:95], v[62:63]
    v_exp_f32 v103, v103
    v_pk_fma_f32 v[96:97], v[96:97], v[122:123], v[122:123]
    v_pk_fma_f32 v[98:99], v[98:99], v[122:123], v[122:123]
    v_pk_fma_f32 v[100:101], v[100:101], v[122:123], v[122:123]
    v_pk_fma_f32 v[102:103], v[102:103], v[122:123], v[122:123]
    v_rcp_f32 v96, v96
    v_rcp_f32 v97, v97
    v_rcp_f32 v98, v98
    v_rcp_f32 v99, v99
    v_rcp_f32 v100, v100
    v_rcp_f32 v101, v101
    v_rcp_f32 v102, v102
    v_rcp_f32 v103, v103
    v_pk_mul_f32 v[88:89], v[88:89], v[96:97]
    v_pk_mul_f32 v[90:91], v[90:91], v[98:99]
    v_pk_mul_f32 v[92:93], v[92:93], v[100:101]
    v_pk_mul_f32 v[94:95], v[94:95], v[102:103]
    v_cvt_pk_bf16_f32 v108, v88, v89
    v_cvt_pk_bf16_f32 v109, v90, v91
    v_cvt_pk_bf16_f32 v110, v92, v93
    v_cvt_pk_bf16_f32 v111, v94, v95
    buffer_store_dwordx4 v[108:111], v28, s[24:27], s5 offen offset:512 sc1
L_join:
L_iw0_0:
    s_cbranch_execz L_iwret
    s_cmp_eq_u32 s55, 1
    s_cbranch_scc1 L_kvok
    s_mov_b32 s57, 16384
L_kv_loop:
    buffer_load_dword v30, v29, s[24:27], s100 offen sc1
    s_waitcnt vmcnt(0)
    v_cmp_ne_u32 vcc, s53, v30
    s_cmp_lg_u64 vcc, 0
    s_cbranch_scc0 L_kv_ok
    s_sub_u32 s57, s57, 1
    s_cbranch_scc0 L_kv_loop
L_kv_ok:
    s_lshr_b32 s58, s3, 2
    s_mul_i32 s59, s58, 8768
    s_lshl_b32 s58, s58, 4
    v_lshl_add_u32 v24, v0, 5, s58
    s_lshl_b32 s58, s3, 10
    s_add_u32 s59, s59, s58
    s_add_u32 m0, s59, 98304
    s_and_b32 s58, s54, 0x1800
    s_lshl_b32 s59, s61, 13
    s_add_u32 s58, s58, s59
    s_add_u32 s58, s58, 1048576
    buffer_load_dwordx4 v24, s[24:27], s58 offen sc1 lds
L_iw1_0:
    s_cbranch_execz L_iwret
    s_waitcnt vmcnt(0)
L_kvok:
    s_lshr_b32 s40, s3, 2
    s_and_b32 s41, s3, 3
    s_mul_i32 s42, s40, 12864
    s_add_u32 s42, s42, 98304
    s_lshl_b32 s6, s41, 7
    s_add_u32 s6, s6, s42
    s_add_u32 s7, s6, 480
    v_and_b32 v15, 15, v0
    v_and_b32 v16, 48, v0
    v_lshlrev_b32 v31, 5, v15
    v_sub_u32 v31, v16, v31
    v_add_u32 v2, s7, v31
    s_add_u32 s7, s6, 11812
    v_and_b32 v31, 1, v0
    v_mul_u32_u24 v31, 4160, v31
    v_sub_u32 v31, v16, v31
    v_bfe_u32 v3, v0, 1, 3
    v_lshl_add_u32 v31, v3, 2, v31
    v_add_u32 v3, s7, v31
    s_cmp_eq_u32 s56, 0
    s_cbranch_scc1 L_nowr
    s_waitcnt vmcnt(12)
L_nowr:
    s_waitcnt lgkmcnt(0)
    s_barrier
    s_or_b32 s6, s2, s3
    s_cbranch_scc1 L_noep
    s_mov_b64 exec, 1
    buffer_store_dword v17, off, s[24:27], 0 offset:0 sc1
    s_mov_b64 exec, -1
L_noep:
    ds_read2_b32 v[128:129], v3 offset0:128 offset1:129
    ds_read2_b32 v[130:131], v3 offset0:130 offset1:131
    ds_read_b128 v[64:67], v2 offset:3584
    ds_read2_b32 v[132:133], v3 offset0:0 offset1:1
    ds_read2_b32 v[134:135], v3 offset0:2 offset1:3
    ds_read_b128 v[68:71], v2 offset:3072
    v_subrev_u32 v3, 1024, v3
    ds_read2_b32 v[136:137], v3 offset0:128 offset1:129
    ds_read2_b32 v[138:139], v3 offset0:130 offset1:131
    ds_read_b128 v[72:75], v2 offset:2560
    ds_read_b128 v[76:79], v2 offset:2048
    ds_read_b128 v[80:83], v2 offset:1536
    ds_read_b128 v[84:87], v2 offset:1024
L_iw2_0:
    s_cbranch_execz L_iwret
    ds_read_b128 v[88:91], v2 offset:512
    ds_read_b128 v[92:95], v2 offset:0
    s_waitcnt lgkmcnt(11)
    v_mfma_f32_16x16x32_bf16 v[60:63], v[128:131], v[64:67], 0
    ds_read2_b32 v[140:141], v3 offset0:0 offset1:1
    ds_read2_b32 v[142:143], v3 offset0:2 offset1:3
    s_waitcnt lgkmcnt(11)
    v_mfma_f32_16x16x32_bf16 v[56:59], v[132:135], v[64:67], 0
    s_and_b32 s43, s49, 3
    s_lshl_b32 s6, s48, 3
    s_add_u32 s6, s6, s3
    s_lshl_b32 s44, s6, 13
    s_lshl_b32 s7, s49, 7
    s_add_u32 s44, s44, s7
    s_lshl_b32 s6, s6, 6
    s_add_u32 s45, s6, 32768
    v_and_b32 v31, 3, v0
    v_lshrrev_b32 v1, 5, v0
    v_lshl_add_u32 v31, v1, 2, v31
    v_and_b32 v30, 28, v0
    v_lshlrev_b32 v30, 2, v30
    v_lshl_add_u32 v30, v31, 10, v30
    v_lshlrev_b32 v1, 3, v31
    s_add_u32 s59, s67, 20480
    buffer_load_dwordx4 v[228:231], v5, s[24:27], s59 offen sc1
    s_waitcnt lgkmcnt(10)
    v_mfma_f32_16x16x32_bf16 v[60:63], v[132:135], v[68:71], v[60:63]
    s_cmp_eq_u32 s56, 0
    s_cbranch_scc1 L_nohf
    s_waitcnt vmcnt(1)
    s_mov_b64 exec, 1
    buffer_store_dword v17, off, s[24:27], s36 offset:4 sc1
    s_mov_b64 exec, -1
L_nohf:
    v_subrev_u32 v3, 1024, v3
    ds_read2_b32 v[128:129], v3 offset0:128 offset1:129
    ds_read2_b32 v[130:131], v3 offset0:130 offset1:131
    s_waitcnt lgkmcnt(10)
    v_mfma_f32_16x16x32_bf16 v[52:55], v[136:139], v[64:67], 0
    s_add_u32 s59, s68, 20480
    buffer_load_dwordx4 v[232:235], v5, s[24:27], s59 offen sc1
    v_mfma_f32_16x16x32_bf16 v[56:59], v[136:139], v[68:71], v[56:59]
    s_mul_i32 s50, s48, 229376
L_iw3_0:
    s_cbranch_execz L_iwret
    s_mul_i32 s7, s3, 7168
    s_add_u32 s50, s50, s7
    s_mul_i32 s7, s70, 3072
    s_add_u32 s50, s50, s7
    s_add_u32 s50, s50, 8388608
    s_mul_i32 s71, s70, 7168
    s_sub_u32 s71, s71, 4096
    s_lshl_b32 s101, s48, 3
    s_add_u32 s101, s101, s3
    s_mul_i32 s101, s101, 896
    s_add_u32 s101, s101, 262148
    v_min_u32 v19, 6, v0
    v_lshlrev_b32 v19, 7, v19
    s_waitcnt lgkmcnt(9)
    v_mfma_f32_16x16x32_bf16 v[60:63], v[136:139], v[72:75], v[60:63]
    ds_read2_b32 v[132:133], v3 offset0:0 offset1:1
    ds_read2_b32 v[134:135], v3 offset0:2 offset1:3
    s_waitcnt lgkmcnt(4)
    v_mfma_f32_16x16x32_bf16 v[48:51], v[140:143], v[64:67], 0
    s_add_u32 s59, s69, 20480
    buffer_load_dwordx4 v[236:239], v5, s[24:27], s59 offen sc1
    v_mfma_f32_16x16x32_bf16 v[52:55], v[140:143], v[68:71], v[52:55]
    buffer_load_dwordx4 v[6:9], v30, s[8:11], s44 offen
    v_mfma_f32_16x16x32_bf16 v[56:59], v[140:143], v[72:75], v[56:59]
    buffer_load_dword v29, v1, s[24:27], s45 offen sc1
    v_mfma_f32_16x16x32_bf16 v[60:63], v[140:143], v[76:79], v[60:63]
    v_subrev_u32 v3, 1024, v3
    ds_read2_b32 v[136:137], v3 offset0:128 offset1:129
    ds_read2_b32 v[138:139], v3 offset0:130 offset1:131
    s_waitcnt lgkmcnt(4)
    v_mfma_f32_16x16x32_bf16 v[44:47], v[128:131], v[64:67], 0
    s_add_u32 s59, s66, 24576
    buffer_load_dwordx4 v[240:243], v5, s[24:27], s59 offen sc1
    v_mfma_f32_16x16x32_bf16 v[48:51], v[128:131], v[68:71], v[48:51]
    ds_read_b128 v[96:99], v2 offset:3648
    v_mfma_f32_16x16x32_bf16 v[52:55], v[128:131], v[72:75], v[52:55]
L_iw4_0:
    s_cbranch_execz L_iwret
    v_mfma_f32_16x16x32_bf16 v[56:59], v[128:131], v[76:79], v[56:59]
    ds_read_b128 v[100:103], v2 offset:3136
    v_mfma_f32_16x16x32_bf16 v[60:63], v[128:131], v[80:83], v[60:63]
    ds_read2_b32 v[140:141], v3 offset0:0 offset1:1
    ds_read2_b32 v[142:143], v3 offset0:2 offset1:3
    s_waitcnt lgkmcnt(6)
    v_mfma_f32_16x16x32_bf16 v[40:43], v[132:135], v[64:67], 0
    s_add_u32 s59, s67, 24576
    buffer_load_dwordx4 v[244:247], v5, s[24:27], s59 offen sc1
    v_mfma_f32_16x16x32_bf16 v[44:47], v[132:135], v[68:71], v[44:47]
    v_mfma_f32_16x16x32_bf16 v[48:51], v[132:135], v[72:75], v[48:51]
    ds_read_b128 v[104:107], v2 offset:2624
    v_mfma_f32_16x16x32_bf16 v[52:55], v[132:135], v[76:79], v[52:55]
    v_mfma_f32_16x16x32_bf16 v[56:59], v[132:135], v[80:83], v[56:59]
    ds_read_b128 v[108:111], v2 offset:2112
    v_mfma_f32_16x16x32_bf16 v[60:63], v[132:135], v[84:87], v[60:63]
    ds_read2_b32 v[128:129], v3 offset0:16 offset1:17
    ds_read2_b32 v[130:131], v3 offset0:18 offset1:19
    s_waitcnt lgkmcnt(8)
    v_mfma_f32_16x16x32_bf16 v[36:39], v[136:139], v[64:67], 0
    s_add_u32 s59, s68, 24576
    buffer_load_dwordx4 v[248:251], v5, s[24:27], s59 offen sc1
    s_add_u32 s59, s69, 24576
    buffer_load_dwordx4 v[252:255], v5, s[24:27], s59 offen sc1
    v_mfma_f32_16x16x32_bf16 v[40:43], v[136:139], v[68:71], v[40:43]
    ds_read_b128 v[112:115], v2 offset:1600
    ds_read_b128 v[116:119], v2 offset:1088
    v_mfma_f32_16x16x32_bf16 v[44:47], v[136:139], v[72:75], v[44:47]
    v_bfe_u32 v20, v0, 1, 2
    v_bfe_u32 v21, v0, 3, 1
    v_mfma_f32_16x16x32_bf16 v[48:51], v[136:139], v[76:79], v[48:51]
    v_xor_b32 v20, v20, v21
    v_lshlrev_b32 v20, 4, v20
L_iw5_0:
    s_cbranch_execz L_iwret
    v_mfma_f32_16x16x32_bf16 v[52:55], v[136:139], v[80:83], v[52:55]
    v_xor_b32 v20, v20, v16
    v_lshl_add_u32 v20, v15, 6, v20
    v_mfma_f32_16x16x32_bf16 v[56:59], v[136:139], v[84:87], v[56:59]
    s_lshl_b32 s6, s3, 13
    v_add_u32 v4, s6, v20
    v_mfma_f32_16x16x32_bf16 v[60:63], v[136:139], v[88:91], v[60:63]
    v_bfe_u32 v20, v0, 2, 2
    v_mov_b32 v18, 0
    s_mov_b64 exec, 0xff
    buffer_atomic_or v18, v19, s[24:27], s101 offen sc0 sc1
    s_mov_b64 exec, -1
    ds_read2_b32 v[132:133], v3 offset0:144 offset1:145
    ds_read2_b32 v[134:135], v3 offset0:146 offset1:147
    s_waitcnt lgkmcnt(8)
    v_mfma_f32_16x16x32_bf16 v[32:35], v[140:143], v[64:67], 0
    ds_read_b128 v[120:123], v2 offset:576
    ds_read_b128 v[124:127], v2 offset:64
    v_mfma_f32_16x16x32_bf16 v[36:39], v[140:143], v[68:71], v[36:39]
    v_bfe_u32 v21, v0, 4, 1
    v_mfma_f32_16x16x32_bf16 v[40:43], v[140:143], v[72:75], v[40:43]
    v_xor_b32 v20, v20, v21
    v_lshlrev_b32 v20, 4, v20
    v_mfma_f32_16x16x32_bf16 v[44:47], v[140:143], v[76:79], v[44:47]
    v_lshlrev_b32 v21, 5, v0
    v_mfma_f32_16x16x32_bf16 v[48:51], v[140:143], v[80:83], v[48:51]
    v_xor_b32 v20, v20, v21
    v_mfma_f32_16x16x32_bf16 v[52:55], v[140:143], v[84:87], v[52:55]
    s_lshl_b32 s6, s40, 15
    s_lshl_b32 s7, s41, 11
    v_mfma_f32_16x16x32_bf16 v[56:59], v[140:143], v[88:91], v[56:59]
    s_add_u32 s6, s6, s7
    v_mfma_f32_16x16x32_bf16 v[60:63], v[140:143], v[92:95], v[60:63]
    v_add_u32 v10, s6, v20
    v_add_u32 v3, 1024, v3
    ds_read2_b32 v[136:137], v3 offset0:16 offset1:17
    ds_read2_b32 v[138:139], v3 offset0:18 offset1:19
    s_waitcnt lgkmcnt(8)
    v_mfma_f32_16x16x32_bf16 v[32:35], v[128:131], v[96:99], v[32:35]
L_iw6_0:
    s_cbranch_execz L_iwret
    s_waitcnt vmcnt(5)
    v_lshlrev_b32 v20, 16, v29
    v_mfma_f32_16x16x32_bf16 v[36:39], v[128:131], v[100:103], v[36:39]
    v_and_b32 v21, 0xffff0000, v29
    v_mfma_f32_16x16x32_bf16 v[40:43], v[128:131], v[104:107], v[40:43]
    v_rcp_f32 v20, v20
    v_mfma_f32_16x16x32_bf16 v[44:47], v[128:131], v[108:111], v[44:47]
    s_waitcnt lgkmcnt(7)
    v_mfma_f32_16x16x32_bf16 v[48:51], v[128:131], v[112:115], v[48:51]
    v_lshlrev_b32 v22, 16, v6
    s_waitcnt lgkmcnt(6)
    v_mfma_f32_16x16x32_bf16 v[52:55], v[128:131], v[116:119], v[52:55]
    v_and_b32 v23, 0xffff0000, v6
    s_waitcnt lgkmcnt(3)
    v_mfma_f32_16x16x32_bf16 v[56:59], v[128:131], v[120:123], v[56:59]
    v_lshlrev_b32 v24, 16, v7
    s_waitcnt lgkmcnt(2)
    v_mfma_f32_16x16x32_bf16 v[60:63], v[128:131], v[124:127], v[60:63]
    ds_read2_b32 v[140:141], v3 offset0:144 offset1:145
    ds_read2_b32 v[142:143], v3 offset0:146 offset1:147
    v_mfma_f32_16x16x32_bf16 v[36:39], v[132:135], v[96:99], v[36:39]
    v_and_b32 v25, 0xffff0000, v7
    v_lshlrev_b32 v26, 16, v8
    v_mfma_f32_16x16x32_bf16 v[40:43], v[132:135], v[100:103], v[40:43]
    ds_write_b128 v4, v[32:35] offset:0
    v_mfma_f32_16x16x32_bf16 v[44:47], v[132:135], v[104:107], v[44:47]
    v_and_b32 v27, 0xffff0000, v8
    v_mfma_f32_16x16x32_bf16 v[48:51], v[132:135], v[108:111], v[48:51]
    v_lshlrev_b32 v28, 16, v9
    v_mfma_f32_16x16x32_bf16 v[52:55], v[132:135], v[112:115], v[52:55]
    v_and_b32 v29, 0xffff0000, v9
    v_mfma_f32_16x16x32_bf16 v[56:59], v[132:135], v[116:119], v[56:59]
    v_add_f32 v22, v22, v21
    v_mfma_f32_16x16x32_bf16 v[60:63], v[132:135], v[120:123], v[60:63]
    v_add_f32 v23, v23, v21
    v_add_u32 v3, 1024, v3
    ds_read2_b32 v[128:129], v3 offset0:16 offset1:17
    ds_read2_b32 v[130:131], v3 offset0:18 offset1:19
L_iw7_0:
    s_cbranch_execz L_iwret
    s_waitcnt lgkmcnt(5)
    v_mfma_f32_16x16x32_bf16 v[40:43], v[136:139], v[96:99], v[40:43]
    v_add_f32 v24, v24, v21
    v_add_f32 v25, v25, v21
    v_mfma_f32_16x16x32_bf16 v[44:47], v[136:139], v[100:103], v[44:47]
    ds_write_b128 v4, v[36:39] offset:1024
    v_mfma_f32_16x16x32_bf16 v[48:51], v[136:139], v[104:107], v[48:51]
    v_add_f32 v26, v26, v21
    v_mfma_f32_16x16x32_bf16 v[52:55], v[136:139], v[108:111], v[52:55]
    v_add_f32 v27, v27, v21
    v_add_f32 v28, v28, v21
    v_mfma_f32_16x16x32_bf16 v[56:59], v[136:139], v[112:115], v[56:59]
    v_add_f32 v29, v29, v21
    v_mfma_f32_16x16x32_bf16 v[60:63], v[136:139], v[116:119], v[60:63]
    v_mul_f32 v22, v22, v20
    ds_read2_b32 v[132:133], v3 offset0:144 offset1:145
    ds_read2_b32 v[134:135], v3 offset0:146 offset1:147
    s_waitcnt lgkmcnt(6)
    v_mfma_f32_16x16x32_bf16 v[44:47], v[140:143], v[96:99], v[44:47]
    v_mul_f32 v23, v23, v20
    v_mul_f32 v24, v24, v20
    v_mfma_f32_16x16x32_bf16 v[48:51], v[140:143], v[100:103], v[48:51]
    ds_write_b128 v4, v[40:43] offset:2048
    v_mul_f32 v25, v25, v20
    v_mfma_f32_16x16x32_bf16 v[52:55], v[140:143], v[104:107], v[52:55]
    v_mul_f32 v26, v26, v20
    v_mfma_f32_16x16x32_bf16 v[56:59], v[140:143], v[108:111], v[56:59]
    v_mul_f32 v27, v27, v20
    v_mul_f32 v28, v28, v20
    v_mfma_f32_16x16x32_bf16 v[60:63], v[140:143], v[112:115], v[60:63]
    v_mul_f32 v29, v29, v20
    v_add_u32 v3, 1024, v3
    ds_read2_b32 v[136:137], v3 offset0:16 offset1:17
    ds_read2_b32 v[138:139], v3 offset0:18 offset1:19
    s_waitcnt vmcnt(0)
    v_cmp_ne_u32 vcc, s53, v18
    s_and_b32 vcc_lo, vcc_lo, 0xff
    s_cselect_b64 s[98:99], 0, -1
    s_waitcnt lgkmcnt(6)
    v_mfma_f32_16x16x32_bf16 v[48:51], v[128:131], v[96:99], v[48:51]
    s_xor_b32 s59, s43, 0
    s_mul_i32 s59, s59, 57344
L_iw8_0:
    s_cbranch_execz L_iwret
    s_add_u32 s4, s50, s59
    s_sub_u32 s5, s4, s71
    s_mov_b64 exec, s[98:99]
    buffer_load_dwordx4 v[64:67], v5, s[24:27], s4 offen offset:0 sc1
    s_mov_b64 exec, -1
    v_mfma_f32_16x16x32_bf16 v[52:55], v[128:131], v[100:103], v[52:55]
    ds_write_b128 v4, v[44:47] offset:3072
    v_mfma_f32_16x16x32_bf16 v[56:59], v[128:131], v[104:107], v[56:59]
    s_mov_b64 exec, s[98:99]
    buffer_load_dwordx4 v[68:71], v5, s[24:27], s4 offen offset:1024 sc1
    s_mov_b64 exec, -1
    v_mfma_f32_16x16x32_bf16 v[60:63], v[128:131], v[108:111], v[60:63]
    ds_read2_b32 v[140:141], v3 offset0:144 offset1:145
    ds_read2_b32 v[142:143], v3 offset0:146 offset1:147
    s_waitcnt lgkmcnt(6)
    v_mfma_f32_16x16x32_bf16 v[52:55], v[132:135], v[96:99], v[52:55]
    ds_write_b128 v4, v[48:51] offset:4096
    s_mov_b64 exec, s[98:99]
    buffer_load_dwordx4 v[72:75], v5, s[24:27], s4 offen offset:2048 sc1
    s_mov_b64 exec, -1
    v_mfma_f32_16x16x32_bf16 v[56:59], v[132:135], v[100:103], v[56:59]
    s_cmp_lg_u32 s98, 0
    s_cbranch_scc1 L_nof2
    v_mov_b32 v18, 0
    s_mov_b64 exec, 0xff
    buffer_atomic_or v18, v19, s[24:27], s101 offen sc0 sc1
    s_mov_b64 exec, -1
L_nof2:
    v_mfma_f32_16x16x32_bf16 v[60:63], v[132:135], v[104:107], v[60:63]
    s_mov_b64 exec, s[98:99]
    buffer_load_dwordx4 v[76:79], v5, s[24:27], s4 offen offset:3072 sc1
    s_mov_b64 exec, -1
    s_waitcnt lgkmcnt(4)
    v_mfma_f32_16x16x32_bf16 v[56:59], v[136:139], v[96:99], v[56:59]
    s_mov_b64 exec, s[98:99]
    buffer_load_dwordx4 v[80:83], v5, s[24:27], s5 offen offset:0 sc1
    s_mov_b64 exec, -1
    ds_write_b128 v4, v[52:55] offset:5120
    v_mfma_f32_16x16x32_bf16 v[60:63], v[136:139], v[100:103], v[60:63]
    s_mov_b64 exec, s[98:99]
    buffer_load_dwordx4 v[84:87], v5, s[24:27], s5 offen offset:1024 sc1
    s_mov_b64 exec, -1
    s_waitcnt lgkmcnt(2)
L_iw9_0:
    s_cbranch_execz L_iwret
    v_mfma_f32_16x16x32_bf16 v[60:63], v[140:143], v[96:99], v[60:63]
    s_mov_b64 exec, s[98:99]
    buffer_load_dwordx4 v[88:91], v5, s[24:27], s5 offen offset:2048 sc1
    s_mov_b64 exec, -1
    ds_write_b128 v4, v[56:59] offset:6144
    s_xor_b32 s59, s43, 1
    s_mul_i32 s59, s59, 57344
    s_add_u32 s4, s50, s59
    s_sub_u32 s5, s4, s71
    s_mov_b64 exec, s[98:99]
    buffer_load_dwordx4 v[92:95], v5, s[24:27], s4 offen offset:0 sc1
    s_mov_b64 exec, -1
    s_lshl_b32 s7, s41, 10
    s_sub_u32 s7, s42, s7
    s_add_u32 s7, s7, 4080
    v_sub_u32 v20, s7, v5
    v_xor_b32 v21, 16, v10
    ds_write_b128 v4, v[60:63] offset:7168
    s_cmp_lg_u32 s98, 0
    s_cbranch_scc1 L_hlate
    s_waitcnt vmcnt(0)
    v_cmp_ne_u32 vcc, s53, v18
    s_and_b32 vcc_lo, vcc_lo, 0xff
    s_cselect_b64 s[98:99], 0, -1
    s_cbranch_scc1 L_hlate
    s_xor_b32 s59, s43, 0
    s_mul_i32 s59, s59, 57344
    s_add_u32 s4, s50, s59
    s_sub_u32 s5, s4, s71
    buffer_load_dwordx4 v[64:67], v5, s[24:27], s4 offen offset:0 sc1
    buffer_load_dwordx4 v[68:71], v5, s[24:27], s4 offen offset:1024 sc1
    buffer_load_dwordx4 v[72:75], v5, s[24:27], s4 offen offset:2048 sc1
    buffer_load_dwordx4 v[76:79], v5, s[24:27], s4 offen offset:3072 sc1
    buffer_load_dwordx4 v[80:83], v5, s[24:27], s5 offen offset:0 sc1
    buffer_load_dwordx4 v[84:87], v5, s[24:27], s5 offen offset:1024 sc1
    buffer_load_dwordx4 v[88:91], v5, s[24:27], s5 offen offset:2048 sc1
    s_xor_b32 s59, s43, 1
    s_mul_i32 s59, s59, 57344
    s_add_u32 s4, s50, s59
    s_sub_u32 s5, s4, s71
    buffer_load_dwordx4 v[92:95], v5, s[24:27], s4 offen offset:0 sc1
L_hlate:
    s_waitcnt lgkmcnt(0)
    s_barrier
    ds_read_b128 v[128:131], v20
L_iw10_0:
    s_cbranch_execz L_iwret
    ds_read_b128 v[32:35], v10 offset:0
    ds_read_b128 v[36:39], v21 offset:0
    ds_read_b128 v[40:43], v10 offset:8192
    ds_read_b128 v[44:47], v21 offset:8192
    ds_read_b128 v[48:51], v10 offset:16384
    ds_read_b128 v[52:55], v21 offset:16384
    ds_read_b128 v[56:59], v10 offset:24576
    ds_read_b128 v[60:63], v21 offset:24576
    s_lshl_b32 s7, s40, 4
    s_lshr_b32 s65, s65, s7
    s_lshl_b32 s65, s65, 16
    s_lshl_b32 s7, s61, 13
    s_lshl_b32 s59, s3, 10
    s_add_u32 s7, s7, s59
    s_add_u32 s7, s7, 5242880
    s_lshl_b32 s64, s41, 9
    s_lshl_b32 s59, s61, 1
    s_add_u32 s64, s64, s59
    s_add_u32 s64, s64, s40
    s_lshl_b32 s59, s64, 7
    s_and_b32 s59, s59, 0x380
    v_xor_b32 v31, s59, v5
    s_lshl_b32 s64, s64, 7
    s_add_u32 s64, s64, 524288
    s_waitcnt lgkmcnt(8)
    v_and_b32 v138, 0xffff0000, v128
    v_lshlrev_b32 v139, 16, v128
    v_and_b32 v136, 0xffff0000, v129
    v_lshlrev_b32 v137, 16, v129
    v_and_b32 v134, 0xffff0000, v130
    v_lshlrev_b32 v135, 16, v130
    v_and_b32 v132, 0xffff0000, v131
    v_lshlrev_b32 v133, 16, v131
    s_waitcnt lgkmcnt(6)
    v_fma_f32 v132, v132, s65, v32
    v_fma_f32 v133, v133, s65, v33
    v_fma_f32 v134, v134, s65, v34
    v_fma_f32 v135, v135, s65, v35
    v_fma_f32 v136, v136, s65, v36
    v_fma_f32 v137, v137, s65, v37
    v_fma_f32 v138, v138, s65, v38
L_iw11_0:
    s_cbranch_execz L_iwret
    v_fma_f32 v139, v139, s65, v39
    s_waitcnt lgkmcnt(2)
    v_add_f32 v40, v40, v48
    v_add_f32 v41, v41, v49
    v_add_f32 v42, v42, v50
    v_add_f32 v43, v43, v51
    v_add_f32 v44, v44, v52
    v_add_f32 v45, v45, v53
    v_add_f32 v46, v46, v54
    v_add_f32 v47, v47, v55
    s_waitcnt lgkmcnt(0)
    s_lshl_b32 s59, s3, 2
    s_add_u32 s59, s59, 102400
    v_mov_b32 v20, s59
    ds_write_b32 v20, v17
    v_add_f32 v132, v132, v56
    v_add_f32 v133, v133, v57
    v_add_f32 v134, v134, v58
    v_add_f32 v135, v135, v59
    v_add_f32 v136, v136, v60
    v_add_f32 v137, v137, v61
    v_add_f32 v138, v138, v62
    v_add_f32 v139, v139, v63
    v_add_f32 v132, v132, v40
    v_add_f32 v133, v133, v41
    v_add_f32 v134, v134, v42
    v_add_f32 v135, v135, v43
    v_add_f32 v136, v136, v44
    v_add_f32 v137, v137, v45
    v_add_f32 v138, v138, v46
    v_add_f32 v139, v139, v47
    v_cvt_pk_bf16_f32 v128, v132, v133
    v_cvt_pk_bf16_f32 v129, v134, v135
    v_cvt_pk_bf16_f32 v130, v136, v137
    v_cvt_pk_bf16_f32 v131, v138, v139
    buffer_store_dwordx4 v[128:131], v31, s[24:27], s7 offen sc1
    s_cmp_lg_u32 s98, 0
    s_cbranch_scc1 L_hgo
    s_mov_b32 s57, 16384
L_hf_loop:
    v_mov_b32 v18, 0
    s_mov_b64 exec, 0xff
    buffer_atomic_or v18, v19, s[24:27], s101 offen sc0 sc1
    s_mov_b64 exec, -1
    s_waitcnt vmcnt(0)
    v_cmp_ne_u32 vcc, s53, v18
    s_and_b32 vcc_lo, vcc_lo, 0xff
    s_cbranch_scc0 L_hf_ok
    s_sub_u32 s57, s57, 1
    s_cbranch_scc0 L_hf_loop
L_hf_ok:
    s_xor_b32 s59, s43, 0
    s_mul_i32 s59, s59, 57344
L_iw12_0:
    s_cbranch_execz L_iwret
    s_add_u32 s4, s50, s59
    s_sub_u32 s5, s4, s71
    buffer_load_dwordx4 v[64:67], v5, s[24:27], s4 offen offset:0 sc1
    buffer_load_dwordx4 v[68:71], v5, s[24:27], s4 offen offset:1024 sc1
    buffer_load_dwordx4 v[72:75], v5, s[24:27], s4 offen offset:2048 sc1
    buffer_load_dwordx4 v[76:79], v5, s[24:27], s4 offen offset:3072 sc1
    buffer_load_dwordx4 v[80:83], v5, s[24:27], s5 offen offset:0 sc1
    buffer_load_dwordx4 v[84:87], v5, s[24:27], s5 offen offset:1024 sc1
    buffer_load_dwordx4 v[88:91], v5, s[24:27], s5 offen offset:2048 sc1
    s_xor_b32 s59, s43, 1
    s_mul_i32 s59, s59, 57344
    s_add_u32 s4, s50, s59
    s_sub_u32 s5, s4, s71
    buffer_load_dwordx4 v[92:95], v5, s[24:27], s4 offen offset:0 sc1
    s_mov_b64 exec, 1
    buffer_store_dword v17, off, s[24:27], s64 offset:4 sc1
    s_mov_b64 exec, -1
L_hgo:
    s_waitcnt vmcnt(8)
    v_mfma_f32_16x16x32_bf16 v[32:35], v[144:147], v[64:67], 0
    v_lshrrev_b32 v20, 4, v0
    s_lshl_b32 s7, s62, 2
    v_xor_b32 v21, v20, v15
    v_mfma_f32_16x16x32_bf16 v[36:39], v[148:151], v[64:67], 0
    v_xor_b32 v21, s7, v21
    v_lshlrev_b32 v21, 4, v21
    v_mfma_f32_16x16x32_bf16 v[40:43], v[152:155], v[64:67], 0
    v_lshl_add_u32 v21, v15, 8, v21
    s_lshl_b32 s7, s3, 12
    v_add_u32 v11, s7, v21
    v_mfma_f32_16x16x32_bf16 v[44:47], v[156:159], v[64:67], 0
    s_lshl_b32 s7, s3, 1
    v_lshrrev_b32 v1, 5, v0
    buffer_load_dwordx4 v[124:127], v5, s[24:27], s4 offen offset:1024 sc1
    s_waitcnt vmcnt(8)
    v_mfma_f32_16x16x32_bf16 v[32:35], v[160:163], v[68:71], v[32:35]
    v_add_u32 v21, s7, v1
    v_and_b32 v20, 3, v0
    v_xor_b32 v31, s43, v20
    v_mfma_f32_16x16x32_bf16 v[36:39], v[164:167], v[68:71], v[36:39]
    v_lshrrev_b32 v12, 1, v0
    v_and_b32 v12, 14, v12
    v_mfma_f32_16x16x32_bf16 v[40:43], v[168:171], v[68:71], v[40:43]
    v_xor_b32 v12, v12, v21
L_iw13_0:
    s_cbranch_execz L_iwret
    v_xor_b32 v12, v12, v31
    v_lshlrev_b32 v12, 4, v12
    v_mfma_f32_16x16x32_bf16 v[44:47], v[172:175], v[68:71], v[44:47]
    v_lshl_add_u32 v12, v21, 8, v12
    s_mov_b32 s7, 16778242
    buffer_load_dwordx4 v[120:123], v5, s[24:27], s4 offen offset:2048 sc1
    s_waitcnt vmcnt(8)
    v_mfma_f32_16x16x32_bf16 v[32:35], v[176:179], v[72:75], v[32:35]
    v_lshlrev_b32 v31, 3, v31
    v_bfe_u32 v31, s7, v31, 8
    v_lshl_add_u32 v12, v31, 15, v12
    v_mfma_f32_16x16x32_bf16 v[36:39], v[180:183], v[72:75], v[36:39]
    v_bfe_u32 v31, v0, 4, 1
    v_lshl_add_u32 v20, v31, 2, v20
    v_xor_b32 v21, s3, v20
    v_mfma_f32_16x16x32_bf16 v[40:43], v[184:187], v[72:75], v[40:43]
    v_lshlrev_b32 v21, 4, v21
    v_lshl_add_u32 v21, v1, 3, v21
    v_lshl_add_u32 v21, v20, 10, v21
    v_mfma_f32_16x16x32_bf16 v[44:47], v[188:191], v[72:75], v[44:47]
    v_bfe_u32 v31, v0, 2, 2
    v_lshl_add_u32 v21, v31, 7, v21
    buffer_load_dwordx4 v[116:119], v5, s[24:27], s4 offen offset:3072 sc1
    s_waitcnt vmcnt(8)
    v_mfma_f32_16x16x32_bf16 v[32:35], v[192:195], v[76:79], v[32:35]
    v_add_u32 v14, 102912, v21
    v_and_b32 v21, 7, v0
    s_lshl_b32 s67, s3, 1
    v_mfma_f32_16x16x32_bf16 v[36:39], v[196:199], v[76:79], v[36:39]
    v_xor_b32 v20, s67, v21
    v_lshlrev_b32 v20, 4, v20
    v_mfma_f32_16x16x32_bf16 v[40:43], v[200:203], v[76:79], v[40:43]
    v_lshrrev_b32 v31, 3, v0
    v_lshl_add_u32 v20, v31, 12, v20
    s_and_b32 s7, s48, 7
    v_mfma_f32_16x16x32_bf16 v[44:47], v[204:207], v[76:79], v[44:47]
    v_xor_b32 v31, s7, v31
    v_lshl_add_u32 v13, v31, 7, v20
    buffer_load_dwordx4 v[112:115], v5, s[24:27], s5 offen offset:0 sc1
L_iw14_0:
    s_cbranch_execz L_iwret
    s_waitcnt vmcnt(8)
    s_waitcnt vmcnt(4)
    s_mov_b64 exec, 1
    buffer_store_dword v17, off, s[24:27], s64 offset:4 sc1
    s_mov_b64 exec, -1
    v_mfma_f32_16x16x32_bf16 v[32:35], v[208:211], v[80:83], v[32:35]
    v_lshlrev_b32 v19, 7, v15
    v_lshlrev_b32 v1, 2, v21
    v_add_u32 v1, 102400, v1
    v_mfma_f32_16x16x32_bf16 v[36:39], v[212:215], v[80:83], v[36:39]
    s_lshl_b32 s7, s49, 3
    s_add_u32 s7, s7, s67
    v_mfma_f32_16x16x32_bf16 v[40:43], v[216:219], v[80:83], v[40:43]
    s_lshl_b32 s66, s7, 15
    s_and_b32 s6, s48, 24
    s_lshl_b32 s6, s6, 7
    v_mfma_f32_16x16x32_bf16 v[44:47], v[220:223], v[80:83], v[44:47]
    s_add_u32 s66, s66, s6
    s_add_u32 s66, s66, 5242880
    buffer_load_dwordx4 v[108:111], v5, s[24:27], s5 offen offset:1024 sc1
    v_mfma_f32_16x16x32_bf16 v[32:35], v[224:227], v[84:87], v[32:35]
    s_lshl_b32 s101, s7, 10
    s_lshr_b32 s6, s48, 3
    s_lshl_b32 s6, s6, 16
    v_mfma_f32_16x16x32_bf16 v[36:39], v[228:231], v[84:87], v[36:39]
    s_add_u32 s101, s101, s6
    s_add_u32 s101, s101, 524292
    s_mov_b32 s36, 0xbfb8aa3b
    v_mfma_f32_16x16x32_bf16 v[40:43], v[232:235], v[84:87], v[40:43]
    s_mov_b32 s37, s36
    s_mov_b32 s38, 1.0
    s_mov_b32 s39, 1.0
    v_mfma_f32_16x16x32_bf16 v[44:47], v[236:239], v[84:87], v[44:47]
    s_lshl_b32 s6, s67, 10
    s_add_u32 m0, s6, 102912
    buffer_load_dwordx4 v[104:107], v5, s[24:27], s5 offen offset:2048 sc1
    v_mfma_f32_16x16x32_bf16 v[32:35], v[240:243], v[88:91], v[32:35]
    v_mfma_f32_16x16x32_bf16 v[36:39], v[244:247], v[88:91], v[36:39]
    v_mfma_f32_16x16x32_bf16 v[40:43], v[248:251], v[88:91], v[40:43]
    v_mfma_f32_16x16x32_bf16 v[44:47], v[252:255], v[88:91], v[44:47]
    s_xor_b32 s59, s43, 2
    s_mul_i32 s59, s59, 57344
L_iw15_0:
    s_cbranch_execz L_iwret
    s_add_u32 s4, s50, s59
    s_sub_u32 s5, s4, s71
    buffer_load_dwordx4 v[100:103], v5, s[24:27], s4 offen offset:0 sc1
    v_mfma_f32_16x16x32_bf16 v[48:51], v[144:147], v[92:95], 0
    v_mfma_f32_16x16x32_bf16 v[52:55], v[148:151], v[92:95], 0
    v_mfma_f32_16x16x32_bf16 v[56:59], v[152:155], v[92:95], 0
    v_mfma_f32_16x16x32_bf16 v[60:63], v[156:159], v[92:95], 0
    buffer_load_dwordx4 v[96:99], v5, s[24:27], s4 offen offset:1024 sc1
    s_waitcnt vmcnt(8)
    v_mfma_f32_16x16x32_bf16 v[48:51], v[160:163], v[124:127], v[48:51]
    v_xor_b32 v20, 65536, v11
    ds_write_b128 v20, v[32:35] offset:0
    v_mfma_f32_16x16x32_bf16 v[52:55], v[164:167], v[124:127], v[52:55]
    v_mfma_f32_16x16x32_bf16 v[56:59], v[168:171], v[124:127], v[56:59]
    v_xor_b32 v20, 65600, v11
    ds_write_b128 v20, v[36:39] offset:0
    v_mfma_f32_16x16x32_bf16 v[60:63], v[172:175], v[124:127], v[60:63]
    buffer_load_dwordx4 v[64:67], v5, s[24:27], s4 offen offset:2048 sc1
    s_waitcnt vmcnt(8)
    v_mfma_f32_16x16x32_bf16 v[48:51], v[176:179], v[120:123], v[48:51]
    v_xor_b32 v20, 65664, v11
    ds_write_b128 v20, v[40:43] offset:0
    v_mfma_f32_16x16x32_bf16 v[52:55], v[180:183], v[120:123], v[52:55]
    v_mfma_f32_16x16x32_bf16 v[56:59], v[184:187], v[120:123], v[56:59]
    v_xor_b32 v20, 65728, v11
    ds_write_b128 v20, v[44:47] offset:0
    v_mfma_f32_16x16x32_bf16 v[60:63], v[188:191], v[120:123], v[60:63]
    buffer_load_dwordx4 v[68:71], v5, s[24:27], s4 offen offset:3072 sc1
    s_waitcnt vmcnt(8)
    v_mfma_f32_16x16x32_bf16 v[48:51], v[192:195], v[116:119], v[48:51]
    v_mfma_f32_16x16x32_bf16 v[52:55], v[196:199], v[116:119], v[52:55]
    v_mfma_f32_16x16x32_bf16 v[56:59], v[200:203], v[116:119], v[56:59]
    v_mfma_f32_16x16x32_bf16 v[60:63], v[204:207], v[116:119], v[60:63]
    buffer_load_dwordx4 v[72:75], v5, s[24:27], s5 offen offset:0 sc1
L_iw16_0:
    s_cbranch_execz L_iwret
    s_waitcnt vmcnt(8)
    v_mfma_f32_16x16x32_bf16 v[48:51], v[208:211], v[112:115], v[48:51]
    v_mfma_f32_16x16x32_bf16 v[52:55], v[212:215], v[112:115], v[52:55]
    v_mfma_f32_16x16x32_bf16 v[56:59], v[216:219], v[112:115], v[56:59]
    v_mfma_f32_16x16x32_bf16 v[60:63], v[220:223], v[112:115], v[60:63]
    buffer_load_dwordx4 v[76:79], v5, s[24:27], s5 offen offset:1024 sc1
    s_waitcnt vmcnt(7)
    v_mfma_f32_16x16x32_bf16 v[48:51], v[224:227], v[108:111], v[48:51]
    v_lshlrev_b32 v128, 16, v6
    v_mfma_f32_16x16x32_bf16 v[52:55], v[228:231], v[108:111], v[52:55]
    v_and_b32 v129, 0xffff0000, v6
    v_mfma_f32_16x16x32_bf16 v[56:59], v[232:235], v[108:111], v[56:59]
    v_lshlrev_b32 v130, 16, v7
    v_mfma_f32_16x16x32_bf16 v[60:63], v[236:239], v[108:111], v[60:63]
    v_and_b32 v131, 0xffff0000, v7
    buffer_load_dwordx4 v[80:83], v5, s[24:27], s5 offen offset:2048 sc1
    s_waitcnt vmcnt(7)
    v_mfma_f32_16x16x32_bf16 v[48:51], v[240:243], v[104:107], v[48:51]
    v_lshlrev_b32 v132, 16, v8
    v_mfma_f32_16x16x32_bf16 v[52:55], v[244:247], v[104:107], v[52:55]
    v_and_b32 v133, 0xffff0000, v8
    v_mfma_f32_16x16x32_bf16 v[56:59], v[248:251], v[104:107], v[56:59]
    v_lshlrev_b32 v134, 16, v9
    v_mfma_f32_16x16x32_bf16 v[60:63], v[252:255], v[104:107], v[60:63]
    v_and_b32 v135, 0xffff0000, v9
    s_xor_b32 s59, s43, 3
    s_mul_i32 s59, s59, 57344
    s_add_u32 s4, s50, s59
    s_sub_u32 s5, s4, s71
    buffer_load_dwordx4 v[84:87], v5, s[24:27], s4 offen offset:0 sc1
    s_waitcnt vmcnt(7)
    s_waitcnt lgkmcnt(0)
    v_mfma_f32_16x16x32_bf16 v[32:35], v[144:147], v[100:103], 0
    v_mfma_f32_16x16x32_bf16 v[36:39], v[148:151], v[100:103], 0
    v_mfma_f32_16x16x32_bf16 v[40:43], v[152:155], v[100:103], 0
    v_mfma_f32_16x16x32_bf16 v[44:47], v[156:159], v[100:103], 0
    buffer_load_dwordx4 v[88:91], v5, s[24:27], s4 offen offset:1024 sc1
L_iw17_0:
    s_cbranch_execz L_iwret
    s_waitcnt vmcnt(7)
    v_mfma_f32_16x16x32_bf16 v[32:35], v[160:163], v[96:99], v[32:35]
    v_xor_b32 v20, 131088, v11
    ds_write_b128 v20, v[48:51] offset:0
    v_mfma_f32_16x16x32_bf16 v[36:39], v[164:167], v[96:99], v[36:39]
    v_mfma_f32_16x16x32_bf16 v[40:43], v[168:171], v[96:99], v[40:43]
    v_xor_b32 v20, 131152, v11
    ds_write_b128 v20, v[52:55] offset:0
    v_mfma_f32_16x16x32_bf16 v[44:47], v[172:175], v[96:99], v[44:47]
    buffer_load_dwordx4 v[92:95], v5, s[24:27], s4 offen offset:2048 sc1
    s_waitcnt vmcnt(7)
    v_mfma_f32_16x16x32_bf16 v[32:35], v[176:179], v[64:67], v[32:35]
    v_xor_b32 v20, 131216, v11
    ds_write_b128 v20, v[56:59] offset:0
    v_mfma_f32_16x16x32_bf16 v[36:39], v[180:183], v[64:67], v[36:39]
    v_mfma_f32_16x16x32_bf16 v[40:43], v[184:187], v[64:67], v[40:43]
    v_xor_b32 v20, 131280, v11
    ds_write_b128 v20, v[60:63] offset:0
    v_mfma_f32_16x16x32_bf16 v[44:47], v[188:191], v[64:67], v[44:47]
    buffer_load_dwordx4 v[124:127], v5, s[24:27], s4 offen offset:3072 sc1
    s_waitcnt vmcnt(7)
    v_mfma_f32_16x16x32_bf16 v[32:35], v[192:195], v[68:71], v[32:35]
    v_mfma_f32_16x16x32_bf16 v[36:39], v[196:199], v[68:71], v[36:39]
    v_mfma_f32_16x16x32_bf16 v[40:43], v[200:203], v[68:71], v[40:43]
    v_mfma_f32_16x16x32_bf16 v[44:47], v[204:207], v[68:71], v[44:47]
    buffer_load_dwordx4 v[120:123], v5, s[24:27], s5 offen offset:0 sc1
    s_waitcnt vmcnt(7)
    v_mfma_f32_16x16x32_bf16 v[32:35], v[208:211], v[72:75], v[32:35]
    v_mfma_f32_16x16x32_bf16 v[36:39], v[212:215], v[72:75], v[36:39]
    v_mfma_f32_16x16x32_bf16 v[40:43], v[216:219], v[72:75], v[40:43]
    v_mfma_f32_16x16x32_bf16 v[44:47], v[220:223], v[72:75], v[44:47]
    buffer_load_dwordx4 v[116:119], v5, s[24:27], s5 offen offset:1024 sc1
    s_waitcnt vmcnt(7)
    v_mfma_f32_16x16x32_bf16 v[32:35], v[224:227], v[76:79], v[32:35]
L_iw18_0:
    s_cbranch_execz L_iwret
    v_mfma_f32_16x16x32_bf16 v[36:39], v[228:231], v[76:79], v[36:39]
    v_mfma_f32_16x16x32_bf16 v[40:43], v[232:235], v[76:79], v[40:43]
    v_mfma_f32_16x16x32_bf16 v[44:47], v[236:239], v[76:79], v[44:47]
    buffer_load_dwordx4 v[112:115], v5, s[24:27], s5 offen offset:2048 sc1
    s_waitcnt vmcnt(7)
    v_mfma_f32_16x16x32_bf16 v[32:35], v[240:243], v[80:83], v[32:35]
    ds_read_b32 v31, v1
    v_mfma_f32_16x16x32_bf16 v[36:39], v[244:247], v[80:83], v[36:39]
    v_mfma_f32_16x16x32_bf16 v[40:43], v[248:251], v[80:83], v[40:43]
    v_mfma_f32_16x16x32_bf16 v[44:47], v[252:255], v[80:83], v[44:47]
    s_waitcnt vmcnt(6)
    s_waitcnt lgkmcnt(1)
    v_mfma_f32_16x16x32_bf16 v[48:51], v[144:147], v[84:87], 0
    v_mfma_f32_16x16x32_bf16 v[52:55], v[148:151], v[84:87], 0
    v_mfma_f32_16x16x32_bf16 v[56:59], v[152:155], v[84:87], 0
    v_mfma_f32_16x16x32_bf16 v[60:63], v[156:159], v[84:87], 0
    s_waitcnt vmcnt(5)
    s_waitcnt lgkmcnt(0)
    v_cmp_eq_u32 vcc, 0, v31
    s_cmp_lg_u64 vcc, 0
    s_cbranch_scc0 L_cn_ok
    s_mov_b32 s57, 16384
L_cn_loop:
    ds_read_b32 v31, v1
    s_waitcnt lgkmcnt(0)
    v_cmp_eq_u32 vcc, 0, v31
    s_cmp_lg_u64 vcc, 0
    s_cbranch_scc0 L_cn_ok
    s_sub_u32 s57, s57, 1
    s_cbranch_scc0 L_cn_loop
L_cn_ok:
    v_mfma_f32_16x16x32_bf16 v[48:51], v[160:163], v[88:91], v[48:51]
    v_xor_b32 v20, 32, v11
    ds_write_b128 v20, v[32:35] offset:0
    v_mfma_f32_16x16x32_bf16 v[52:55], v[164:167], v[88:91], v[52:55]
    v_mfma_f32_16x16x32_bf16 v[56:59], v[168:171], v[88:91], v[56:59]
    v_xor_b32 v20, 96, v11
    ds_write_b128 v20, v[36:39] offset:0
    v_mfma_f32_16x16x32_bf16 v[60:63], v[172:175], v[88:91], v[60:63]
    s_waitcnt vmcnt(4)
    v_mfma_f32_16x16x32_bf16 v[48:51], v[176:179], v[92:95], v[48:51]
    v_xor_b32 v20, 160, v11
L_iw19_0:
    s_cbranch_execz L_iwret
    ds_write_b128 v20, v[40:43] offset:0
    v_mfma_f32_16x16x32_bf16 v[52:55], v[180:183], v[92:95], v[52:55]
    v_mfma_f32_16x16x32_bf16 v[56:59], v[184:187], v[92:95], v[56:59]
    v_xor_b32 v20, 224, v11
    ds_write_b128 v20, v[44:47] offset:0
    v_mfma_f32_16x16x32_bf16 v[60:63], v[188:191], v[92:95], v[60:63]
    s_waitcnt vmcnt(3)
    v_mfma_f32_16x16x32_bf16 v[48:51], v[192:195], v[124:127], v[48:51]
    v_mfma_f32_16x16x32_bf16 v[52:55], v[196:199], v[124:127], v[52:55]
    v_mfma_f32_16x16x32_bf16 v[56:59], v[200:203], v[124:127], v[56:59]
    v_mfma_f32_16x16x32_bf16 v[60:63], v[204:207], v[124:127], v[60:63]
    s_waitcnt vmcnt(0)
    s_cmp_ge_u32 s3, 4
    s_cbranch_scc1 L_nyp
    v_mov_b32 v18, 0
    s_mov_b64 exec, 0xffff
    buffer_atomic_or v18, v19, s[24:27], s101 offen sc0 sc1
    s_mov_b64 exec, -1
L_nyp:
    v_mfma_f32_16x16x32_bf16 v[48:51], v[208:211], v[120:123], v[48:51]
    v_mfma_f32_16x16x32_bf16 v[52:55], v[212:215], v[120:123], v[52:55]
    v_mfma_f32_16x16x32_bf16 v[56:59], v[216:219], v[120:123], v[56:59]
    v_mfma_f32_16x16x32_bf16 v[60:63], v[220:223], v[120:123], v[60:63]
    v_mfma_f32_16x16x32_bf16 v[48:51], v[224:227], v[116:119], v[48:51]
    v_mfma_f32_16x16x32_bf16 v[52:55], v[228:231], v[116:119], v[52:55]
    v_mfma_f32_16x16x32_bf16 v[56:59], v[232:235], v[116:119], v[56:59]
    v_mfma_f32_16x16x32_bf16 v[60:63], v[236:239], v[116:119], v[60:63]
    v_mfma_f32_16x16x32_bf16 v[48:51], v[240:243], v[112:115], v[48:51]
    s_cmp_ge_u32 s3, 4
    s_cselect_b32 s98, -1, 0
    s_cbranch_scc1 L_ylate
    s_waitcnt vmcnt(0)
    v_cmp_ne_u32 vcc, s53, v18
    s_and_b32 vcc_lo, vcc_lo, 0xffff
    s_cselect_b32 s98, 0, -1
    s_cbranch_scc1 L_ylate
    buffer_load_dwordx4 v13, s[24:27], s66 offen sc1 lds
    v_xor_b32 v18, 16, v13
    s_add_u32 m0, m0, 1024
L_iw20_0:
    s_cbranch_execz L_iwret
    s_add_u32 s66, s66, 32768
    buffer_load_dwordx4 v18, s[24:27], s66 offen sc1 lds
L_ylate:
    v_mfma_f32_16x16x32_bf16 v[52:55], v[244:247], v[112:115], v[52:55]
    v_mfma_f32_16x16x32_bf16 v[56:59], v[248:251], v[112:115], v[56:59]
    v_xor_b32 v21, 16, v12
    v_mfma_f32_16x16x32_bf16 v[60:63], v[252:255], v[112:115], v[60:63]
    v_xor_b32 v20, 48, v11
    ds_write_b128 v20, v[48:51] offset:32768
    v_xor_b32 v20, 112, v11
    s_nop 1
    ds_write_b128 v20, v[52:55] offset:32768
    v_xor_b32 v20, 176, v11
    ds_write_b128 v20, v[56:59] offset:32768
    v_xor_b32 v20, 240, v11
    ds_write_b128 v20, v[60:63] offset:32768
    s_cmp_lg_u32 s98, 0
    s_cbranch_scc1 L_ygo
    s_mov_b32 s57, 16384
L_yf_loop:
    v_mov_b32 v18, 0
    s_mov_b64 exec, 0xffff
    buffer_atomic_or v18, v19, s[24:27], s101 offen sc0 sc1
    s_mov_b64 exec, -1
    s_waitcnt vmcnt(0)
    v_cmp_ne_u32 vcc, s53, v18
    s_and_b32 vcc_lo, vcc_lo, 0xffff
    s_cbranch_scc0 L_yf_ok
    s_sub_u32 s57, s57, 1
    s_cbranch_scc0 L_yf_loop
L_yf_ok:
    buffer_load_dwordx4 v13, s[24:27], s66 offen sc1 lds
    v_xor_b32 v18, 16, v13
    s_add_u32 m0, m0, 1024
    s_add_u32 s66, s66, 32768
    buffer_load_dwordx4 v18, s[24:27], s66 offen sc1 lds
L_ygo:
    s_waitcnt vmcnt(0) lgkmcnt(0)
    s_barrier
    ds_read_b64_tr_b16 v[136:137], v14
    ds_read_b64_tr_b16 v[138:139], v14 offset:512
    ds_read_b128 v[64:67], v12 offset:0
    ds_read_b128 v[68:71], v21 offset:0
L_iw21_0:
    s_cbranch_execz L_iwret
    ds_read_b128 v[72:75], v12 offset:4096
    ds_read_b128 v[76:79], v21 offset:4096
    ds_read_b128 v[80:83], v12 offset:8192
    ds_read_b128 v[84:87], v21 offset:8192
    ds_read_b128 v[88:91], v12 offset:12288
    ds_read_b128 v[92:95], v21 offset:12288
    ds_read_b128 v[96:99], v12 offset:16384
    ds_read_b128 v[100:103], v21 offset:16384
    ds_read_b128 v[104:107], v12 offset:20480
    ds_read_b128 v[108:111], v21 offset:20480
    s_waitcnt lgkmcnt(12)
    v_lshlrev_b32 v32, 16, v136
    v_and_b32 v33, 0xffff0000, v136
    v_lshlrev_b32 v34, 16, v137
    v_and_b32 v35, 0xffff0000, v137
    v_lshlrev_b32 v36, 16, v138
    v_and_b32 v37, 0xffff0000, v138
    v_lshlrev_b32 v38, 16, v139
    v_and_b32 v39, 0xffff0000, v139
    ds_read_b128 v[112:115], v12 offset:24576
    ds_read_b128 v[116:119], v21 offset:24576
    ds_read_b128 v[120:123], v12 offset:28672
    ds_read_b128 v[124:127], v21 offset:28672
    v_pk_mul_f32 v[22:23], v[22:23], v[32:33]
    v_pk_mul_f32 v[24:25], v[24:25], v[34:35]
    v_pk_mul_f32 v[26:27], v[26:27], v[36:37]
    v_pk_mul_f32 v[28:29], v[28:29], v[38:39]
    s_waitcnt lgkmcnt(12)
    v_pk_add_f32 v[64:65], v[64:65], v[72:73]
    v_pk_add_f32 v[66:67], v[66:67], v[74:75]
    v_pk_add_f32 v[68:69], v[68:69], v[76:77]
    v_pk_add_f32 v[70:71], v[70:71], v[78:79]
    s_waitcnt lgkmcnt(10)
    v_pk_add_f32 v[64:65], v[64:65], v[80:81]
    v_pk_add_f32 v[66:67], v[66:67], v[82:83]
L_iw22_0:
    s_cbranch_execz L_iw22_1
    v_pk_add_f32 v[68:69], v[68:69], v[84:85]
    v_pk_add_f32 v[70:71], v[70:71], v[86:87]
    s_waitcnt lgkmcnt(8)
    v_pk_add_f32 v[64:65], v[64:65], v[88:89]
    v_pk_add_f32 v[66:67], v[66:67], v[90:91]
    v_pk_add_f32 v[68:69], v[68:69], v[92:93]
    v_pk_add_f32 v[70:71], v[70:71], v[94:95]
    s_waitcnt lgkmcnt(6)
    v_pk_add_f32 v[64:65], v[64:65], v[96:97]
    v_pk_add_f32 v[66:67], v[66:67], v[98:99]
    v_pk_add_f32 v[68:69], v[68:69], v[100:101]
    v_pk_add_f32 v[70:71], v[70:71], v[102:103]
    s_waitcnt lgkmcnt(4)
    v_pk_add_f32 v[64:65], v[64:65], v[104:105]
    v_pk_add_f32 v[66:67], v[66:67], v[106:107]
    v_pk_add_f32 v[68:69], v[68:69], v[108:109]
    v_pk_add_f32 v[70:71], v[70:71], v[110:111]
    s_waitcnt lgkmcnt(2)
    v_pk_add_f32 v[64:65], v[64:65], v[112:113]
    v_pk_add_f32 v[66:67], v[66:67], v[114:115]
    v_pk_add_f32 v[68:69], v[68:69], v[116:117]
    v_pk_add_f32 v[70:71], v[70:71], v[118:119]
    s_waitcnt lgkmcnt(0)
    v_pk_add_f32 v[64:65], v[64:65], v[120:121]
    v_pk_add_f32 v[66:67], v[66:67], v[122:123]
    v_pk_add_f32 v[68:69], v[68:69], v[124:125]
    v_pk_add_f32 v[70:71], v[70:71], v[126:127]
    v_pk_mul_f32 v[32:33], v[64:65], s[36:37]
    v_pk_mul_f32 v[34:35], v[66:67], s[36:37]
    v_pk_mul_f32 v[36:37], v[68:69], s[36:37]
    v_pk_mul_f32 v[38:39], v[70:71], s[36:37]
    v_exp_f32 v32, v32
    v_pk_mul_f32 v[22:23], v[22:23], v[64:65]
    v_exp_f32 v33, v33
    v_exp_f32 v34, v34
    v_pk_mul_f32 v[24:25], v[24:25], v[66:67]
L_iw22_1:
    s_cbranch_execz L_iwret
    v_exp_f32 v35, v35
    v_exp_f32 v36, v36
    v_pk_mul_f32 v[26:27], v[26:27], v[68:69]
    v_exp_f32 v37, v37
    v_exp_f32 v38, v38
    v_pk_mul_f32 v[28:29], v[28:29], v[70:71]
    v_exp_f32 v39, v39
    v_pk_add_f32 v[32:33], v[32:33], s[38:39]
    v_pk_add_f32 v[34:35], v[34:35], s[38:39]
    v_pk_add_f32 v[36:37], v[36:37], s[38:39]
    v_pk_add_f32 v[38:39], v[38:39], s[38:39]
    v_rcp_f32 v32, v32
    v_rcp_f32 v33, v33
    v_rcp_f32 v34, v34
    v_rcp_f32 v35, v35
    v_rcp_f32 v36, v36
    v_rcp_f32 v37, v37
    v_rcp_f32 v38, v38
    v_rcp_f32 v39, v39
    v_pk_fma_f32 v[128:129], v[22:23], v[32:33], v[128:129]
    v_pk_fma_f32 v[130:131], v[24:25], v[34:35], v[130:131]
    v_pk_fma_f32 v[132:133], v[26:27], v[36:37], v[132:133]
    v_pk_fma_f32 v[134:135], v[28:29], v[38:39], v[134:135]
    v_cvt_pk_bf16_f32 v136, v128, v129
    v_cvt_pk_bf16_f32 v137, v130, v131
    v_cvt_pk_bf16_f32 v138, v132, v133
    v_cvt_pk_bf16_f32 v139, v134, v135
    buffer_store_dwordx4 v[136:139], v30, s[28:31], s44 offen sc0 sc1
L_end:
    s_endpgm
L_iwb:
L_iwret:
    s_branch L_iwr_a
L_aux:
    buffer_load_dword v17, off, s[24:27], 0 offset:0 sc1
    s_lshl_b32 s98, s48, 3
    s_add_u32 s98, s98, s56
    s_lshl_b32 s98, s98, 3
    s_add_u32 s98, s98, s3
    s_lshl_b32 s58, s98, 10
    buffer_load_dwordx4 v[200:203], v5, s[8:11], s58 offen
    s_xor_b32 s64, s63, s3
    v_and_b32 v23, 1, v21
    v_lshlrev_b32 v23, 1, v23
    v_xor_b32 v23, v22, v23
    v_lshlrev_b32 v23, 4, v23
    v_lshl_add_u32 v1, v20, 10, v23
    v_xor_b32 v2, 64, v1
    s_lshl_b32 s4, s62, 3
    s_add_u32 s4, s4, s3
    s_mov_b32 s50, s4
    s_lshl_b32 s4, s4, 16
    s_lshl_b32 s6, s64, 7
    s_add_u32 s4, s4, s6
    s_mul_i32 s5, s3, 17408
    s_mov_b32 m0, s5
    s_cmp_eq_u32 s50, 0
    s_cbranch_scc1 L_halo0
    s_sub_u32 s6, s4, 8192
    buffer_load_dwordx4 v1, s[36:39], s6 offen lds
    s_branch L_halo1
L_halo0:
    v_mov_b32 v40, 0
    v_mov_b32 v41, 0
    v_mov_b32 v42, 0
    v_mov_b32 v43, 0
    ds_write_b128 v5, v[40:43]
L_halo1:
    s_add_u32 m0, s5, 1024
    s_add_u32 s6, s4, 0
    buffer_load_dwordx4 v2, s[36:39], s6 offen nt lds
    s_add_u32 m0, s5, 9216
    s_add_u32 s6, s4, 0
    buffer_load_dwordx4 v1, s[40:43], s6 offen nt lds
    s_add_u32 m0, s5, 2048
    s_add_u32 s6, s4, 8192
    buffer_load_dwordx4 v1, s[36:39], s6 offen nt lds
    s_add_u32 m0, s5, 10240
    s_add_u32 s6, s4, 8192
    buffer_load_dwordx4 v2, s[40:43], s6 offen nt lds
    s_add_u32 m0, s5, 3072
    s_add_u32 s6, s4, 16384
    buffer_load_dwordx4 v2, s[36:39], s6 offen nt lds
    s_add_u32 m0, s5, 11264
    s_add_u32 s6, s4, 16384
    buffer_load_dwordx4 v1, s[40:43], s6 offen nt lds
    s_add_u32 m0, s5, 4096
    s_add_u32 s6, s4, 24576
    buffer_load_dwordx4 v1, s[36:39], s6 offen nt lds
    s_add_u32 m0, s5, 12288
    s_add_u32 s6, s4, 24576
    buffer_load_dwordx4 v2, s[40:43], s6 offen nt lds
    v_and_b32 v23, 15, v0
    v_lshlrev_b32 v26, 3, v23
    s_lshl_b32 s7, s64, 9
    buffer_load_dwordx2 v[32:33], v26, s[44:47], s7 offen offset:0
    buffer_load_dwordx2 v[34:35], v26, s[44:47], s7 offen offset:128
    buffer_load_dwordx2 v[36:37], v26, s[44:47], s7 offen offset:256
    buffer_load_dwordx2 v[38:39], v26, s[44:47], s7 offen offset:384
    s_add_u32 m0, s5, 5120
    s_add_u32 s6, s4, 32768
    buffer_load_dwordx4 v2, s[36:39], s6 offen nt lds
    s_add_u32 m0, s5, 13312
    s_add_u32 s6, s4, 32768
    buffer_load_dwordx4 v1, s[40:43], s6 offen nt lds
    s_add_u32 m0, s5, 6144
    s_add_u32 s6, s4, 40960
    buffer_load_dwordx4 v1, s[36:39], s6 offen nt lds
    s_add_u32 m0, s5, 14336
    s_add_u32 s6, s4, 40960
    buffer_load_dwordx4 v2, s[40:43], s6 offen nt lds
    s_add_u32 m0, s5, 7168
    s_add_u32 s6, s4, 49152
    buffer_load_dwordx4 v2, s[36:39], s6 offen nt lds
    s_add_u32 m0, s5, 15360
    s_add_u32 s6, s4, 49152
    buffer_load_dwordx4 v1, s[40:43], s6 offen nt lds
    s_add_u32 m0, s5, 8192
    s_add_u32 s6, s4, 57344
    buffer_load_dwordx4 v1, s[36:39], s6 offen nt lds
    s_add_u32 m0, s5, 16384
    s_add_u32 s6, s4, 57344
    buffer_load_dwordx4 v2, s[40:43], s6 offen nt lds
    s_and_b32 s58, s3, 3
    s_lshl_b32 s58, s58, 10
    buffer_load_dwordx4 v[128:131], v5, s[32:35], s58 offen nt
    v_lshlrev_b32 v26, 7, v24
    v_lshl_add_u32 v26, v21, 10, v26
    v_lshl_add_u32 v26, v25, 3, v26
    v_lshrrev_b32 v27, 1, v24
    v_lshl_add_u32 v26, v27, 5, v26
    v_and_b32 v27, 1, v21
    v_lshl_add_u32 v26, v27, 6, v26
    v_add_u32 v6, s5, v26
    v_xor_b32 v7, 32, v6
    v_xor_b32 v8, 64, v6
    v_xor_b32 v9, 96, v6
    v_lshrrev_b32 v26, 1, v23
    v_lshlrev_b32 v26, 13, v26
    v_and_b32 v27, 1, v0
    v_lshl_add_u32 v26, v27, 4, v26
    v_sub_u32 v27, 3, v21
    v_lshl_add_u32 v10, v27, 5, v26
    s_lshl_b32 s4, s64, 18
    s_lshl_b32 s6, s50, 8
    s_sub_u32 s4, s4, s6
    s_add_u32 s4, s4, 1056512
    s_waitcnt vmcnt(21)
    v_add_u32 v17, 1, v17
    v_and_b32 v17, 0x0fff3fff, v17
    v_or_b32 v17, 0x20000000, v17
    s_mov_b32 s99, 0x3f803f80
    v_readfirstlane_b32 s53, v17
    v_dot2_f32_bf16 v204, v200, s99, 0
    v_dot2_f32_bf16 v205, v200, v200, 0
    v_dot2_f32_bf16 v204, v201, s99, v204
    v_dot2_f32_bf16 v205, v201, v201, v205
    v_dot2_f32_bf16 v204, v202, s99, v204
    v_dot2_f32_bf16 v205, v202, v202, v205
    v_dot2_f32_bf16 v204, v203, s99, v204
    v_dot2_f32_bf16 v205, v203, v203, v205
    v_mov_b32 v201, v17
    s_nop 1
    v_permlane32_swap_b32 v204, v205
    v_add_f32 v204, v204, v205
    s_nop 1
    v_add_f32_dpp v204, v204, v204 quad_perm:[1,0,3,2] row_mask:0xf bank_mask:0xf
    s_nop 1
    v_add_f32_dpp v204, v204, v204 quad_perm:[2,3,0,1] row_mask:0xf bank_mask:0xf
    s_nop 1
    v_add_f32_dpp v204, v204, v204 row_half_mirror row_mask:0xf bank_mask:0xf
    s_nop 1
    v_add_f32_dpp v204, v204, v204 row_mirror row_mask:0xf bank_mask:0xf
    s_nop 1
    v_add_f32_dpp v204, v204, v204 row_bcast:15 row_mask:0xa bank_mask:0xf
    v_mul_f32 v204, 0x3b000000, v204
    s_nop 0
    v_readlane_b32 s99, v204, 31
    v_readlane_b32 s100, v204, 63
    s_nop 0
    v_mul_f32 v204, s99, s99
    v_sub_f32 v204, s100, v204
    v_max_f32 v204, 0, v204
    v_cvt_pk_bf16_f32 v204, v204, v204
    v_lshlrev_b32 v204, 16, v204
    v_add_f32 v204, 0x3727c5ac, v204
    v_cvt_pk_bf16_f32 v204, v204, v204
    v_lshlrev_b32 v204, 16, v204
    v_sqrt_f32 v204, v204
    s_lshl_b32 s98, s98, 3
    v_cvt_pk_bf16_f32 v200, v204, -s99
    s_add_u32 s98, s98, 32768
    s_mov_b64 exec, 1
    buffer_store_dwordx2 v[200:201], off, s[24:27], s98 sc1
    s_mov_b64 exec, -1
    s_waitcnt vmcnt(10) lgkmcnt(0)
    ds_read_b64_tr_b16 v[48:49], v6 offset:512
    ds_read_b64_tr_b16 v[50:51], v8 offset:1024
    ds_read_b64_tr_b16 v[52:53], v8 offset:1536
    ds_read_b64_tr_b16 v[54:55], v6 offset:9216
    ds_read_b64_tr_b16 v[56:57], v6 offset:9728
    ds_read_b64_tr_b16 v[58:59], v7 offset:512
    ds_read_b64_tr_b16 v[60:61], v9 offset:1024
    ds_read_b64_tr_b16 v[62:63], v9 offset:1536
    ds_read_b64_tr_b16 v[64:65], v7 offset:9216
    ds_read_b64_tr_b16 v[66:67], v7 offset:9728
    ds_read_b64_tr_b16 v[68:69], v8 offset:512
    ds_read_b64_tr_b16 v[70:71], v6 offset:1024
    ds_read_b64_tr_b16 v[72:73], v6 offset:1536
    ds_read_b64_tr_b16 v[74:75], v8 offset:9216
    ds_read_b64_tr_b16 v[76:77], v8 offset:9728
    ds_read_b64_tr_b16 v[78:79], v9 offset:512
    ds_read_b64_tr_b16 v[80:81], v7 offset:1024
    ds_read_b64_tr_b16 v[82:83], v7 offset:1536
    ds_read_b64_tr_b16 v[84:85], v9 offset:9216
    ds_read_b64_tr_b16 v[86:87], v9 offset:9728
    v_alignbit_b32 v32, v32, v32, 16
    v_alignbit_b32 v33, v33, v33, 16
    v_alignbit_b32 v34, v34, v34, 16
    v_alignbit_b32 v35, v35, v35, 16
    v_alignbit_b32 v36, v36, v36, 16
    v_alignbit_b32 v37, v37, v37, 16
    v_alignbit_b32 v38, v38, v38, 16
    v_alignbit_b32 v39, v39, v39, 16
    s_waitcnt lgkmcnt(15)
    v_alignbit_b32 v97, v49, v48, 16
    v_alignbit_b32 v98, v50, v49, 16
    v_alignbit_b32 v99, v51, v50, 16
    v_alignbit_b32 v100, v52, v51, 16
    v_alignbit_b32 v101, v53, v52, 16
    v_dot2_f32_bf16 v105, v50, v32, 0
    v_dot2_f32_bf16 v107, v51, v32, 0
    v_dot2_f32_bf16 v109, v52, v32, 0
    v_dot2_f32_bf16 v111, v53, v32, 0
    v_dot2_f32_bf16 v104, v98, v32, 0
    v_dot2_f32_bf16 v106, v99, v32, 0
    v_dot2_f32_bf16 v108, v100, v32, 0
    v_dot2_f32_bf16 v110, v101, v32, 0
    v_dot2_f32_bf16 v105, v49, v33, v105
    v_dot2_f32_bf16 v107, v50, v33, v107
    v_dot2_f32_bf16 v109, v51, v33, v109
    v_dot2_f32_bf16 v111, v52, v33, v111
    v_dot2_f32_bf16 v104, v97, v33, v104
    v_dot2_f32_bf16 v106, v98, v33, v106
    v_dot2_f32_bf16 v108, v99, v33, v108
    v_dot2_f32_bf16 v110, v100, v33, v110
    v_lshlrev_b32 v112, 16, v54
    v_and_b32 v113, 0xffff0000, v54
    v_lshlrev_b32 v114, 16, v55
    v_and_b32 v115, 0xffff0000, v55
    v_lshlrev_b32 v116, 16, v56
    v_and_b32 v117, 0xffff0000, v56
    v_lshlrev_b32 v118, 16, v57
    v_and_b32 v119, 0xffff0000, v57
    v_mul_f32 v104, v104, v112
    v_mul_f32 v105, v105, v113
    v_mul_f32 v106, v106, v114
    v_mul_f32 v107, v107, v115
    v_mul_f32 v108, v108, v116
    v_mul_f32 v109, v109, v117
    v_mul_f32 v110, v110, v118
    v_mul_f32 v111, v111, v119
    v_cvt_pk_bf16_f32 v120, v111, v110
    v_cvt_pk_bf16_f32 v121, v109, v108
    v_cvt_pk_bf16_f32 v122, v107, v106
    v_cvt_pk_bf16_f32 v123, v105, v104
    s_add_u32 s6, s4, 0
    buffer_store_dwordx4 v[120:123], v10, s[24:27], s6 offen offset:128 sc1
    s_waitcnt lgkmcnt(10)
    v_alignbit_b32 v97, v59, v58, 16
    v_alignbit_b32 v98, v60, v59, 16
    v_alignbit_b32 v99, v61, v60, 16
    v_alignbit_b32 v100, v62, v61, 16
    v_alignbit_b32 v101, v63, v62, 16
    v_dot2_f32_bf16 v105, v60, v34, 0
    v_dot2_f32_bf16 v107, v61, v34, 0
    v_dot2_f32_bf16 v109, v62, v34, 0
    v_dot2_f32_bf16 v111, v63, v34, 0
    v_dot2_f32_bf16 v104, v98, v34, 0
    v_dot2_f32_bf16 v106, v99, v34, 0
    v_dot2_f32_bf16 v108, v100, v34, 0
    v_dot2_f32_bf16 v110, v101, v34, 0
    v_dot2_f32_bf16 v105, v59, v35, v105
    v_dot2_f32_bf16 v107, v60, v35, v107
    v_dot2_f32_bf16 v109, v61, v35, v109
    v_dot2_f32_bf16 v111, v62, v35, v111
    v_dot2_f32_bf16 v104, v97, v35, v104
    v_dot2_f32_bf16 v106, v98, v35, v106
    v_dot2_f32_bf16 v108, v99, v35, v108
    v_dot2_f32_bf16 v110, v100, v35, v110
    v_lshlrev_b32 v112, 16, v64
    v_and_b32 v113, 0xffff0000, v64
    v_lshlrev_b32 v114, 16, v65
    v_and_b32 v115, 0xffff0000, v65
    v_lshlrev_b32 v116, 16, v66
    v_and_b32 v117, 0xffff0000, v66
    v_lshlrev_b32 v118, 16, v67
    v_and_b32 v119, 0xffff0000, v67
    v_mul_f32 v104, v104, v112
    v_mul_f32 v105, v105, v113
    v_mul_f32 v106, v106, v114
    v_mul_f32 v107, v107, v115
    v_mul_f32 v108, v108, v116
    v_mul_f32 v109, v109, v117
    v_mul_f32 v110, v110, v118
    v_mul_f32 v111, v111, v119
    v_cvt_pk_bf16_f32 v124, v111, v110
    v_cvt_pk_bf16_f32 v125, v109, v108
    v_cvt_pk_bf16_f32 v126, v107, v106
    v_cvt_pk_bf16_f32 v127, v105, v104
    s_add_u32 s6, s4, 65536
    buffer_store_dwordx4 v[124:127], v10, s[24:27], s6 offen offset:128 sc1
    s_waitcnt lgkmcnt(5)
    v_alignbit_b32 v97, v69, v68, 16
    v_alignbit_b32 v98, v70, v69, 16
    v_alignbit_b32 v99, v71, v70, 16
    v_alignbit_b32 v100, v72, v71, 16
    v_alignbit_b32 v101, v73, v72, 16
    v_dot2_f32_bf16 v105, v70, v36, 0
    v_dot2_f32_bf16 v107, v71, v36, 0
    v_dot2_f32_bf16 v109, v72, v36, 0
    v_dot2_f32_bf16 v111, v73, v36, 0
    v_dot2_f32_bf16 v104, v98, v36, 0
    v_dot2_f32_bf16 v106, v99, v36, 0
    v_dot2_f32_bf16 v108, v100, v36, 0
    v_dot2_f32_bf16 v110, v101, v36, 0
    v_dot2_f32_bf16 v105, v69, v37, v105
    v_dot2_f32_bf16 v107, v70, v37, v107
    v_dot2_f32_bf16 v109, v71, v37, v109
    v_dot2_f32_bf16 v111, v72, v37, v111
    v_dot2_f32_bf16 v104, v97, v37, v104
    v_dot2_f32_bf16 v106, v98, v37, v106
    v_dot2_f32_bf16 v108, v99, v37, v108
    v_dot2_f32_bf16 v110, v100, v37, v110
    v_lshlrev_b32 v112, 16, v74
    v_and_b32 v113, 0xffff0000, v74
    v_lshlrev_b32 v114, 16, v75
    v_and_b32 v115, 0xffff0000, v75
    v_lshlrev_b32 v116, 16, v76
    v_and_b32 v117, 0xffff0000, v76
    v_lshlrev_b32 v118, 16, v77
    v_and_b32 v119, 0xffff0000, v77
    v_mul_f32 v104, v104, v112
    v_mul_f32 v105, v105, v113
    v_mul_f32 v106, v106, v114
    v_mul_f32 v107, v107, v115
    v_mul_f32 v108, v108, v116
    v_mul_f32 v109, v109, v117
    v_mul_f32 v110, v110, v118
    v_mul_f32 v111, v111, v119
    v_cvt_pk_bf16_f32 v120, v111, v110
    v_cvt_pk_bf16_f32 v121, v109, v108
    v_cvt_pk_bf16_f32 v122, v107, v106
    v_cvt_pk_bf16_f32 v123, v105, v104
    s_add_u32 s6, s4, 131072
    buffer_store_dwordx4 v[120:123], v10, s[24:27], s6 offen offset:128 sc1
    s_waitcnt lgkmcnt(0)
    v_alignbit_b32 v97, v79, v78, 16
    v_alignbit_b32 v98, v80, v79, 16
    v_alignbit_b32 v99, v81, v80, 16
    v_alignbit_b32 v100, v82, v81, 16
    v_alignbit_b32 v101, v83, v82, 16
    v_dot2_f32_bf16 v105, v80, v38, 0
    v_dot2_f32_bf16 v107, v81, v38, 0
    v_dot2_f32_bf16 v109, v82, v38, 0
    v_dot2_f32_bf16 v111, v83, v38, 0
    v_dot2_f32_bf16 v104, v98, v38, 0
    v_dot2_f32_bf16 v106, v99, v38, 0
    v_dot2_f32_bf16 v108, v100, v38, 0
    v_dot2_f32_bf16 v110, v101, v38, 0
    v_dot2_f32_bf16 v105, v79, v39, v105
    v_dot2_f32_bf16 v107, v80, v39, v107
    v_dot2_f32_bf16 v109, v81, v39, v109
    v_dot2_f32_bf16 v111, v82, v39, v111
    v_dot2_f32_bf16 v104, v97, v39, v104
    v_dot2_f32_bf16 v106, v98, v39, v106
    v_dot2_f32_bf16 v108, v99, v39, v108
    v_dot2_f32_bf16 v110, v100, v39, v110
    v_lshlrev_b32 v112, 16, v84
    v_and_b32 v113, 0xffff0000, v84
    v_lshlrev_b32 v114, 16, v85
    v_and_b32 v115, 0xffff0000, v85
    v_lshlrev_b32 v116, 16, v86
    v_and_b32 v117, 0xffff0000, v86
    v_lshlrev_b32 v118, 16, v87
    v_and_b32 v119, 0xffff0000, v87
    v_mul_f32 v104, v104, v112
    v_mul_f32 v105, v105, v113
    v_mul_f32 v106, v106, v114
    v_mul_f32 v107, v107, v115
    v_mul_f32 v108, v108, v116
    v_mul_f32 v109, v109, v117
    v_mul_f32 v110, v110, v118
    v_mul_f32 v111, v111, v119
    v_cvt_pk_bf16_f32 v124, v111, v110
    v_cvt_pk_bf16_f32 v125, v109, v108
    v_cvt_pk_bf16_f32 v126, v107, v106
    v_cvt_pk_bf16_f32 v127, v105, v104
    s_add_u32 s6, s4, 196608
    buffer_store_dwordx4 v[124:127], v10, s[24:27], s6 offen offset:128 sc1
    s_waitcnt vmcnt(6) lgkmcnt(0)
    ds_read_b64_tr_b16 v[48:49], v6 offset:4608
    ds_read_b64_tr_b16 v[50:51], v8 offset:5120
    ds_read_b64_tr_b16 v[52:53], v8 offset:5632
    ds_read_b64_tr_b16 v[54:55], v6 offset:13312
    ds_read_b64_tr_b16 v[56:57], v6 offset:13824
    ds_read_b64_tr_b16 v[58:59], v7 offset:4608
    ds_read_b64_tr_b16 v[60:61], v9 offset:5120
    ds_read_b64_tr_b16 v[62:63], v9 offset:5632
    ds_read_b64_tr_b16 v[64:65], v7 offset:13312
    ds_read_b64_tr_b16 v[66:67], v7 offset:13824
    ds_read_b64_tr_b16 v[68:69], v8 offset:4608
    ds_read_b64_tr_b16 v[70:71], v6 offset:5120
    ds_read_b64_tr_b16 v[72:73], v6 offset:5632
    ds_read_b64_tr_b16 v[74:75], v8 offset:13312
    ds_read_b64_tr_b16 v[76:77], v8 offset:13824
    ds_read_b64_tr_b16 v[78:79], v9 offset:4608
    ds_read_b64_tr_b16 v[80:81], v7 offset:5120
    ds_read_b64_tr_b16 v[82:83], v7 offset:5632
    ds_read_b64_tr_b16 v[84:85], v9 offset:13312
    ds_read_b64_tr_b16 v[86:87], v9 offset:13824
    s_waitcnt lgkmcnt(15)
    v_alignbit_b32 v97, v49, v48, 16
    v_alignbit_b32 v98, v50, v49, 16
    v_alignbit_b32 v99, v51, v50, 16
    v_alignbit_b32 v100, v52, v51, 16
    v_alignbit_b32 v101, v53, v52, 16
    v_dot2_f32_bf16 v105, v50, v32, 0
    v_dot2_f32_bf16 v107, v51, v32, 0
    v_dot2_f32_bf16 v109, v52, v32, 0
    v_dot2_f32_bf16 v111, v53, v32, 0
    v_dot2_f32_bf16 v104, v98, v32, 0
    v_dot2_f32_bf16 v106, v99, v32, 0
    v_dot2_f32_bf16 v108, v100, v32, 0
    v_dot2_f32_bf16 v110, v101, v32, 0
    v_dot2_f32_bf16 v105, v49, v33, v105
    v_dot2_f32_bf16 v107, v50, v33, v107
    v_dot2_f32_bf16 v109, v51, v33, v109
    v_dot2_f32_bf16 v111, v52, v33, v111
    v_dot2_f32_bf16 v104, v97, v33, v104
    v_dot2_f32_bf16 v106, v98, v33, v106
    v_dot2_f32_bf16 v108, v99, v33, v108
    v_dot2_f32_bf16 v110, v100, v33, v110
    v_lshlrev_b32 v112, 16, v54
    v_and_b32 v113, 0xffff0000, v54
    v_lshlrev_b32 v114, 16, v55
    v_and_b32 v115, 0xffff0000, v55
    v_lshlrev_b32 v116, 16, v56
    v_and_b32 v117, 0xffff0000, v56
    v_lshlrev_b32 v118, 16, v57
    v_and_b32 v119, 0xffff0000, v57
    v_mul_f32 v104, v104, v112
    v_mul_f32 v105, v105, v113
    v_mul_f32 v106, v106, v114
    v_mul_f32 v107, v107, v115
    v_mul_f32 v108, v108, v116
    v_mul_f32 v109, v109, v117
    v_mul_f32 v110, v110, v118
    v_mul_f32 v111, v111, v119
    v_cvt_pk_bf16_f32 v120, v111, v110
    v_cvt_pk_bf16_f32 v121, v109, v108
    v_cvt_pk_bf16_f32 v122, v107, v106
    v_cvt_pk_bf16_f32 v123, v105, v104
    s_add_u32 s6, s4, 0
    buffer_store_dwordx4 v[120:123], v10, s[24:27], s6 offen offset:0 sc1
    s_waitcnt lgkmcnt(10)
    v_alignbit_b32 v97, v59, v58, 16
    v_alignbit_b32 v98, v60, v59, 16
    v_alignbit_b32 v99, v61, v60, 16
    v_alignbit_b32 v100, v62, v61, 16
    v_alignbit_b32 v101, v63, v62, 16
    v_dot2_f32_bf16 v105, v60, v34, 0
    v_dot2_f32_bf16 v107, v61, v34, 0
    v_dot2_f32_bf16 v109, v62, v34, 0
    v_dot2_f32_bf16 v111, v63, v34, 0
    v_dot2_f32_bf16 v104, v98, v34, 0
    v_dot2_f32_bf16 v106, v99, v34, 0
    v_dot2_f32_bf16 v108, v100, v34, 0
    v_dot2_f32_bf16 v110, v101, v34, 0
    v_dot2_f32_bf16 v105, v59, v35, v105
    v_dot2_f32_bf16 v107, v60, v35, v107
    v_dot2_f32_bf16 v109, v61, v35, v109
    v_dot2_f32_bf16 v111, v62, v35, v111
    v_dot2_f32_bf16 v104, v97, v35, v104
    v_dot2_f32_bf16 v106, v98, v35, v106
    v_dot2_f32_bf16 v108, v99, v35, v108
    v_dot2_f32_bf16 v110, v100, v35, v110
    v_lshlrev_b32 v112, 16, v64
    v_and_b32 v113, 0xffff0000, v64
    v_lshlrev_b32 v114, 16, v65
    v_and_b32 v115, 0xffff0000, v65
    v_lshlrev_b32 v116, 16, v66
    v_and_b32 v117, 0xffff0000, v66
    v_lshlrev_b32 v118, 16, v67
    v_and_b32 v119, 0xffff0000, v67
    v_mul_f32 v104, v104, v112
    v_mul_f32 v105, v105, v113
    v_mul_f32 v106, v106, v114
    v_mul_f32 v107, v107, v115
    v_mul_f32 v108, v108, v116
    v_mul_f32 v109, v109, v117
    v_mul_f32 v110, v110, v118
    v_mul_f32 v111, v111, v119
    v_cvt_pk_bf16_f32 v124, v111, v110
    v_cvt_pk_bf16_f32 v125, v109, v108
    v_cvt_pk_bf16_f32 v126, v107, v106
    v_cvt_pk_bf16_f32 v127, v105, v104
    s_add_u32 s6, s4, 65536
    buffer_store_dwordx4 v[124:127], v10, s[24:27], s6 offen offset:0 sc1
    s_waitcnt lgkmcnt(5)
    v_alignbit_b32 v97, v69, v68, 16
    v_alignbit_b32 v98, v70, v69, 16
    v_alignbit_b32 v99, v71, v70, 16
    v_alignbit_b32 v100, v72, v71, 16
    v_alignbit_b32 v101, v73, v72, 16
    v_dot2_f32_bf16 v105, v70, v36, 0
    v_dot2_f32_bf16 v107, v71, v36, 0
    v_dot2_f32_bf16 v109, v72, v36, 0
    v_dot2_f32_bf16 v111, v73, v36, 0
    v_dot2_f32_bf16 v104, v98, v36, 0
    v_dot2_f32_bf16 v106, v99, v36, 0
    v_dot2_f32_bf16 v108, v100, v36, 0
    v_dot2_f32_bf16 v110, v101, v36, 0
    v_dot2_f32_bf16 v105, v69, v37, v105
    v_dot2_f32_bf16 v107, v70, v37, v107
    v_dot2_f32_bf16 v109, v71, v37, v109
    v_dot2_f32_bf16 v111, v72, v37, v111
    v_dot2_f32_bf16 v104, v97, v37, v104
    v_dot2_f32_bf16 v106, v98, v37, v106
    v_dot2_f32_bf16 v108, v99, v37, v108
    v_dot2_f32_bf16 v110, v100, v37, v110
    v_lshlrev_b32 v112, 16, v74
    v_and_b32 v113, 0xffff0000, v74
    v_lshlrev_b32 v114, 16, v75
    v_and_b32 v115, 0xffff0000, v75
    v_lshlrev_b32 v116, 16, v76
    v_and_b32 v117, 0xffff0000, v76
    v_lshlrev_b32 v118, 16, v77
    v_and_b32 v119, 0xffff0000, v77
    v_mul_f32 v104, v104, v112
    v_mul_f32 v105, v105, v113
    v_mul_f32 v106, v106, v114
    v_mul_f32 v107, v107, v115
    v_mul_f32 v108, v108, v116
    v_mul_f32 v109, v109, v117
    v_mul_f32 v110, v110, v118
    v_mul_f32 v111, v111, v119
    v_cvt_pk_bf16_f32 v120, v111, v110
    v_cvt_pk_bf16_f32 v121, v109, v108
    v_cvt_pk_bf16_f32 v122, v107, v106
    v_cvt_pk_bf16_f32 v123, v105, v104
    s_add_u32 s6, s4, 131072
    buffer_store_dwordx4 v[120:123], v10, s[24:27], s6 offen offset:0 sc1
    s_waitcnt lgkmcnt(0)
    v_alignbit_b32 v97, v79, v78, 16
    v_alignbit_b32 v98, v80, v79, 16
    v_alignbit_b32 v99, v81, v80, 16
    v_alignbit_b32 v100, v82, v81, 16
    v_alignbit_b32 v101, v83, v82, 16
    v_dot2_f32_bf16 v105, v80, v38, 0
    v_dot2_f32_bf16 v107, v81, v38, 0
    v_dot2_f32_bf16 v109, v82, v38, 0
    v_dot2_f32_bf16 v111, v83, v38, 0
    v_dot2_f32_bf16 v104, v98, v38, 0
    v_dot2_f32_bf16 v106, v99, v38, 0
    v_dot2_f32_bf16 v108, v100, v38, 0
    v_dot2_f32_bf16 v110, v101, v38, 0
    v_dot2_f32_bf16 v105, v79, v39, v105
    v_dot2_f32_bf16 v107, v80, v39, v107
    v_dot2_f32_bf16 v109, v81, v39, v109
    v_dot2_f32_bf16 v111, v82, v39, v111
    v_dot2_f32_bf16 v104, v97, v39, v104
    v_dot2_f32_bf16 v106, v98, v39, v106
    v_dot2_f32_bf16 v108, v99, v39, v108
    v_dot2_f32_bf16 v110, v100, v39, v110
    v_lshlrev_b32 v112, 16, v84
    v_and_b32 v113, 0xffff0000, v84
    v_lshlrev_b32 v114, 16, v85
    v_and_b32 v115, 0xffff0000, v85
    v_lshlrev_b32 v116, 16, v86
    v_and_b32 v117, 0xffff0000, v86
    v_lshlrev_b32 v118, 16, v87
    v_and_b32 v119, 0xffff0000, v87
    v_mul_f32 v104, v104, v112
    v_mul_f32 v105, v105, v113
    v_mul_f32 v106, v106, v114
    v_mul_f32 v107, v107, v115
    v_mul_f32 v108, v108, v116
    v_mul_f32 v109, v109, v117
    v_mul_f32 v110, v110, v118
    v_mul_f32 v111, v111, v119
    v_cvt_pk_bf16_f32 v124, v111, v110
    v_cvt_pk_bf16_f32 v125, v109, v108
    v_cvt_pk_bf16_f32 v126, v107, v106
    v_cvt_pk_bf16_f32 v127, v105, v104
    s_add_u32 s6, s4, 196608
    buffer_store_dwordx4 v[124:127], v10, s[24:27], s6 offen offset:0 sc1
    s_and_b32 s58, s3, 3
    s_cselect_b32 s58, s55, 0
    v_mov_b32 v132, s58
    s_waitcnt vmcnt(9)
    v_alignbit_b32 v135, v129, v128, 16
    v_alignbit_b32 v136, v130, v129, 16
    v_alignbit_b32 v137, v131, v130, 16
    v_mov_b32_dpp v132, v131 wave_shr:1 row_mask:0xf bank_mask:0xf
    v_mov_b32 v140, 0
    v_mov_b32 v141, 0
    v_mov_b32 v142, 0
    v_mov_b32 v143, 0
    v_alignbit_b32 v134, v128, v132, 16
    s_lshr_b32 s58, s3, 2
    s_mul_i32 s58, s58, 12864
    s_add_u32 s58, s58, 98304
    v_min_u32 v133, 35, v0
    v_lshlrev_b32 v133, 4, v133
    v_lshrrev_b32 v132, 5, v0
    v_lshl_add_u32 v133, v132, 12, v133
    v_add_u32 v133, s58, v133
    s_and_b32 s59, s3, 3
    s_lshl_b32 s59, s59, 10
    s_add_u32 s58, s58, s59
    v_add_u32 v132, s58, v5
    s_lshl_b32 s58, s49, 3
    s_add_u32 s58, s58, s3
    s_and_b32 s101, s49, 6
    s_lshl_b32 s101, s101, 1
    s_add_u32 s101, s101, s52
    s_lshl_b32 s101, s101, 1
    s_and_b32 s59, s49, 1
    s_add_u32 s101, s101, s59
    s_lshl_b32 s101, s101, 4
    s_add_u32 s101, s101, s51
    s_lshl_b32 s101, s101, 5
    s_add_u32 s101, s101, 32836
    s_mul_i32 s58, s58, 28672
    s_mul_i32 s59, s70, 12288
    s_add_u32 s58, s58, s59
    s_add_u32 s58, s58, 3145728
    s_lshl_b32 s59, s62, 10
    s_add_u32 s66, s58, s59
    s_xor_b32 s67, s66, 1024
    s_xor_b32 s68, s66, 2048
    s_xor_b32 s69, s66, 3072
    v_min_u32 v19, 27, v0
    v_and_b32 v18, 28, v19
    v_add_u32 v19, v19, v18
    v_lshlrev_b32 v19, 3, v19
    s_lshl_b32 s6, s64, 5
    s_add_u32 s6, s6, s50
    s_lshl_b32 s6, s6, 2
    s_add_u32 s6, s6, 4096
    v_lshlrev_b32 v26, 10, v0
    v_lshlrev_b32 v27, 3, v0
    s_lshl_b32 s98, s48, 9
    s_add_u32 s98, s98, 32772
    s_waitcnt vmcnt(0)
    s_mov_b64 exec, 3
    buffer_store_dword v17, v26, s[24:27], s6 offen sc1
    s_mov_b64 exec, -1
    s_lshl_b32 s57, s3, 2
    s_add_u32 s57, s57, s62
    s_cmp_ge_u32 s57, 23
    s_cbranch_scc1 L_iwr_a
    s_mov_b64 exec, 0
    s_cmp_eq_u32 s57, 0
    s_cbranch_scc1 L_iw0_0
    s_cmp_eq_u32 s57, 1
    s_cbranch_scc1 L_iw1_0
    s_cmp_eq_u32 s57, 2
    s_cbranch_scc1 L_iw2_0
    s_cmp_eq_u32 s57, 3
    s_cbranch_scc1 L_iw3_0
    s_cmp_eq_u32 s57, 4
    s_cbranch_scc1 L_iw4_0
    s_cmp_eq_u32 s57, 5
    s_cbranch_scc1 L_iw5_0
    s_cmp_eq_u32 s57, 6
    s_cbranch_scc1 L_iw6_0
    s_cmp_eq_u32 s57, 7
    s_cbranch_scc1 L_iw7_0
    s_cmp_eq_u32 s57, 8
    s_cbranch_scc1 L_iw8_0
    s_cmp_eq_u32 s57, 9
    s_cbranch_scc1 L_iw9_0
    s_cmp_eq_u32 s57, 10
    s_cbranch_scc1 L_iw10_0
    s_cmp_eq_u32 s57, 11
    s_cbranch_scc1 L_iw11_0
    s_cmp_eq_u32 s57, 12
    s_cbranch_scc1 L_iw12_0
    s_cmp_eq_u32 s57, 13
    s_cbranch_scc1 L_iw13_0
    s_cmp_eq_u32 s57, 14
    s_cbranch_scc1 L_iw14_0
    s_cmp_eq_u32 s57, 15
    s_cbranch_scc1 L_iw15_0
    s_cmp_eq_u32 s57, 16
    s_cbranch_scc1 L_iw16_0
    s_cmp_eq_u32 s57, 17
    s_cbranch_scc1 L_iw17_0
    s_cmp_eq_u32 s57, 18
    s_cbranch_scc1 L_iw18_0
    s_cmp_eq_u32 s57, 19
    s_cbranch_scc1 L_iw19_0
    s_cmp_eq_u32 s57, 20
    s_cbranch_scc1 L_iw20_0
    s_cmp_eq_u32 s57, 21
    s_cbranch_scc1 L_iw21_0
    s_branch L_iw22_0
L_iwr_a:
    s_mov_b64 exec, -1
    s_barrier
    ds_write_b128 v132, v[128:131] offset:4608
    ds_write_b128 v132, v[134:137] offset:8768
    ds_write_b128 v133, v[140:143] offset:4096
    v_and_b32 v29, 31, v0
    v_lshlrev_b32 v29, 2, v29
    s_lshl_b32 s100, s63, 7
    s_add_u32 s100, s100, 4096
    s_add_u32 s100, s100, 1024
    s_mov_b32 s57, 16384
L_fwa_loop:
    buffer_load_dword v18, v19, s[24:27], s101 offen sc1
    buffer_load_dword v28, v27, s[24:27], s98 offen sc1
    s_waitcnt vmcnt(0)
    v_xor_b32 v18, s53, v18
    v_xor_b32 v28, s53, v28
    v_or_b32 v18, v18, v28
    v_cmp_ne_u32 vcc, 0, v18
    s_cmp_lg_u64 vcc, 0
    s_cbranch_scc0 L_fwa_ok
    s_sub_u32 s57, s57, 1
    s_cbranch_scc0 L_fwa_loop
L_fwa_ok:
    s_cmp_lg_u32 s2, 0
    s_cbranch_scc1 L_ep_ok
    s_add_u32 s6, s54, 32768
    s_mov_b32 s57, 16384
L_ep_loop:
    buffer_load_dwordx4 v[32:35], v5, s[24:27], s6 offen sc1
    buffer_load_dwordx4 v[36:39], v5, s[24:27], s6 offen offset:1024 sc1
    s_waitcnt vmcnt(0)
    v_xor_b32 v33, s53, v33
    v_xor_b32 v35, s53, v35
    v_xor_b32 v37, s53, v37
    v_xor_b32 v39, s53, v39
    v_or3_b32 v33, v33, v35, v37
    v_or_b32 v33, v33, v39
    v_cmp_ne_u32 vcc, 0, v33
    s_cmp_lg_u64 vcc, 0
    s_cbranch_scc0 L_ep_ok
    s_sub_u32 s57, s57, 1
    s_cbranch_scc0 L_ep_loop
L_ep_ok:
    s_add_u32 s59, s66, 0
    buffer_load_dwordx4 v[144:147], v5, s[24:27], s59 offen sc1
    s_add_u32 s59, s67, 0
    buffer_load_dwordx4 v[148:151], v5, s[24:27], s59 offen sc1
    s_add_u32 s59, s68, 0
    buffer_load_dwordx4 v[152:155], v5, s[24:27], s59 offen sc1
    s_add_u32 s59, s69, 0
    buffer_load_dwordx4 v[156:159], v5, s[24:27], s59 offen sc1
    s_add_u32 s59, s66, 4096
    buffer_load_dwordx4 v[160:163], v5, s[24:27], s59 offen sc1
    s_add_u32 s59, s67, 4096
    buffer_load_dwordx4 v[164:167], v5, s[24:27], s59 offen sc1
    s_add_u32 s59, s68, 4096
    buffer_load_dwordx4 v[168:171], v5, s[24:27], s59 offen sc1
    s_add_u32 s59, s69, 4096
    buffer_load_dwordx4 v[172:175], v5, s[24:27], s59 offen sc1
    s_add_u32 s59, s66, 8192
    buffer_load_dwordx4 v[176:179], v5, s[24:27], s59 offen sc1
    s_add_u32 s59, s67, 8192
    buffer_load_dwordx4 v[180:183], v5, s[24:27], s59 offen sc1
    s_add_u32 s59, s68, 8192
    buffer_load_dwordx4 v[184:187], v5, s[24:27], s59 offen sc1
    s_add_u32 s59, s69, 8192
    buffer_load_dwordx4 v[188:191], v5, s[24:27], s59 offen sc1
    s_add_u32 s59, s66, 12288
    buffer_load_dwordx4 v[192:195], v5, s[24:27], s59 offen sc1
    s_add_u32 s59, s67, 12288
    buffer_load_dwordx4 v[196:199], v5, s[24:27], s59 offen sc1
    s_add_u32 s59, s68, 12288
    buffer_load_dwordx4 v[200:203], v5, s[24:27], s59 offen sc1
    s_add_u32 s59, s69, 12288
    buffer_load_dwordx4 v[204:207], v5, s[24:27], s59 offen sc1
    s_mul_i32 s59, s70, 28672
    s_sub_u32 s66, s66, s59
    s_sub_u32 s67, s67, s59
    s_sub_u32 s68, s68, s59
    s_sub_u32 s69, s69, s59
    s_add_u32 s59, s66, 16384
    buffer_load_dwordx4 v[208:211], v5, s[24:27], s59 offen sc1
    s_add_u32 s59, s67, 16384
    buffer_load_dwordx4 v[212:215], v5, s[24:27], s59 offen sc1
    s_add_u32 s59, s68, 16384
    buffer_load_dwordx4 v[216:219], v5, s[24:27], s59 offen sc1
    s_add_u32 s59, s69, 16384
    buffer_load_dwordx4 v[220:223], v5, s[24:27], s59 offen sc1
    s_add_u32 s59, s66, 20480
    buffer_load_dwordx4 v[224:227], v5, s[24:27], s59 offen sc1
    s_mov_b32 s57, 16384
L_kva_loop:
    buffer_load_dword v30, v29, s[24:27], s100 offen sc1
    s_waitcnt vmcnt(0)
    v_cmp_ne_u32 vcc, s53, v30
    s_cmp_lg_u64 vcc, 0
    s_cbranch_scc0 L_kva_ok
    s_sub_u32 s57, s57, 1
    s_cbranch_scc0 L_kva_loop
L_kva_ok:
    s_lshr_b32 s58, s3, 2
    s_mul_i32 s59, s58, 8768
    s_lshl_b32 s58, s58, 4
    v_lshl_add_u32 v24, v0, 5, s58
    s_lshl_b32 s58, s3, 10
    s_add_u32 s59, s59, s58
    s_add_u32 m0, s59, 98304
    s_and_b32 s58, s54, 0x1800
    s_lshl_b32 s59, s61, 13
    s_add_u32 s58, s58, s59
    s_add_u32 s58, s58, 1048576
    buffer_load_dwordx4 v24, s[24:27], s58 offen sc1 lds
    s_waitcnt vmcnt(0)
    s_branch L_kvok
    s_endpgm
.section .rodata,"a"
.p2align 6
.amdhsa_kernel recurrent_scan__ssm_conv_h3__geglu_ffn__prompt_kernel
  .amdhsa_next_free_vgpr 256
  .amdhsa_next_free_sgpr 102
  .amdhsa_accum_offset 256
  .amdhsa_group_segment_fixed_size 0
  .amdhsa_kernarg_size 104
  .amdhsa_user_sgpr_count 2
  .amdhsa_user_sgpr_kernarg_segment_ptr 1
  .amdhsa_system_sgpr_workgroup_id_x 1
.end_amdhsa_kernel
```
